```python
import torch

def _softmax(x, axis=-1):
    return torch.softmax(x, dim=axis)
def _gelu(x):
    return torch.nn.functional.gelu(x, approximate="tanh")
def _silu(x):
    return torch.nn.functional.silu(x)
def _sigmoid(x):
    return torch.sigmoid(x)
def _layernorm(x, axis=-1, eps=1e-5):
    m = x.mean(dim=axis, keepdim=True)
    v = x.var(dim=axis, keepdim=True, unbiased=False)
    return (x - m) / torch.sqrt(v + eps)
def _scatter_add(tgt, idx, src, axis=0):
    return tgt.clone().index_add_(axis, idx, src)
def _segment_sum(src, seg, n):
    out = torch.zeros((n,) + src.shape[1:], dtype=src.dtype)
    return out.index_add_(0, seg, src)
def _pad(x, pw):
    flat = tuple(v for pair in reversed(pw) for v in pair)
    return torch.nn.functional.pad(x, flat)

kernel_name = 'standalone__graph_attention_gat__graph'

def setup_inputs():

    _w = (lambda a: (lambda t: t.to(torch.bfloat16) if t.is_floating_point() else t)(torch.as_tensor(a)))
    N, deg, D = 10000, 16, 256
    H = 4
    E = N * deg
    return {
        "x": _w((lambda *s: torch.randn(*s, dtype=torch.bfloat16) * 0.4)(N, D) * 0.1),
        "src": _w((lambda lo, hi, *s: torch.randint(lo, hi, s))(0, N, E).to(torch.int64)),
        "dst": _w((lambda lo, hi, *s: torch.randint(lo, hi, s))(0, N, E).to(torch.int64)),
        "w": _w((lambda *s: torch.randn(*s, dtype=torch.bfloat16) * 1.6)(H, D, D) * (1.0 / D ** 0.5)),
        "a_src": _w((lambda *s: torch.randn(*s, dtype=torch.bfloat16) * 1.6)(H, D) * 0.1),
        "a_dst": _w((lambda *s: torch.randn(*s, dtype=torch.bfloat16) * 1.6)(H, D) * 0.1),
    }

def reference(x, src, dst, w, a_src, a_dst):
    N, D = x.shape
    H = w.shape[0]
    h = torch.einsum('nd,hdf->nhf', x, w)
    hs = h[src]
    hd = h[dst]
    e = torch.einsum('ehf,hf->eh', hs, a_src) + torch.einsum('ehf,hf->eh', hd, a_dst)
    e = torch.where(e > 0, e, 0.2 * e)
    exp_e = torch.exp(e)
    denom = _segment_sum(exp_e, dst, N) + 1e-9
    alpha = exp_e / denom[dst]
    out = _segment_sum(alpha[:, :, None] * hs, dst, N)
    return out.mean(1)
```

```asm
; @launch kernel=gat_prep_kernel grid=(256,1,1) block=(640,1,1) lds=17024
; @launch kernel=gat_main_kernel grid=(250,1,1) block=(512,1,1) lds=132928
.amdgcn_target "amdgcn-amd-amdhsa--gfx950"
.text
.globl gat_prep_kernel
.p2align 8
.type gat_prep_kernel,@function
gat_prep_kernel:
  s_cmp_ge_u32 s2, 256
  s_cbranch_scc1 KA_END
  s_load_dwordx8 s[4:11], s[0:1], 0
  s_load_dwordx4 s[12:15], s[0:1], 32
  s_load_dwordx2 s[16:17], s[0:1], 64
  v_lshrrev_b32 v6, 6, v0
  v_and_b32 v1, 63, v0
  v_and_b32 v2, 15, v1
  v_lshrrev_b32 v3, 4, v1
  v_readfirstlane_b32 s24, v6
  s_lshr_b32 s25, s2, 4
  s_and_b32 s26, s2, 15
  v_mov_b32 v4, 0
  v_mov_b32 v5, 0
  s_waitcnt lgkmcnt(0)
  s_cmp_ge_u32 s2, 250
  s_cbranch_scc1 KA_NOEDGE
  s_mul_i32 s27, s2, 2560
  v_lshl_add_u32 v6, v0, 2, s27
  global_load_dword v4, v6, s[8:9]
  global_load_dword v5, v6, s[6:7]
  s_mul_i32 s27, s2, 640
  s_add_u32 s27, s27, 4194304
  v_lshl_add_u32 v6, v0, 4, s27
  v_mov_b32 v80, -1
  v_mov_b32 v81, -1
  v_mov_b32 v82, -1
  v_mov_b32 v83, -1
  v_cmp_gt_u32 vcc, 40, v0
  s_and_saveexec_b64 s[32:33], vcc
  s_cbranch_execz KA_NORST
  global_store_dwordx4 v6, v[80:83], s[16:17]
KA_NORST:
  s_mov_b64 exec, s[32:33]
KA_NOEDGE:
  s_mov_b32 s36, 0
  s_cmp_ge_u32 s24, 8
  s_cbranch_scc1 KA_SHUF_LOAD
  s_cmp_lg_u32 s24, 0
  s_cbranch_scc1 KA_INIT
  s_cmp_ge_u32 s2, 64
  s_cbranch_scc1 KA_INIT
  s_mov_b32 s36, 1
  v_mov_b32 v72, s12
  v_mov_b32 v73, s13
  v_mov_b32 v74, s14
  v_mov_b32 v75, s15
  v_cmp_eq_u32 vcc, 1, v2
  s_lshl_b32 s27, s25, 9
  v_lshlrev_b32 v76, 4, v3
  v_add_u32 v76, s27, v76
  v_cndmask_b32 v72, v72, v74, vcc
  v_cndmask_b32 v73, v73, v75, vcc
  v_add_co_u32 v72, vcc, v72, v76
  s_nop 1
  v_addc_co_u32 v73, vcc, 0, v73, vcc
  v_mov_b32 v40, 0
  v_mov_b32 v41, 0
  v_mov_b32 v42, 0
  v_mov_b32 v43, 0
  v_mov_b32 v44, 0
  v_mov_b32 v45, 0
  v_mov_b32 v46, 0
  v_mov_b32 v47, 0
  v_mov_b32 v48, 0
  v_mov_b32 v49, 0
  v_mov_b32 v50, 0
  v_mov_b32 v51, 0
  v_mov_b32 v52, 0
  v_mov_b32 v53, 0
  v_mov_b32 v54, 0
  v_mov_b32 v55, 0
  v_mov_b32 v56, 0
  v_mov_b32 v57, 0
  v_mov_b32 v58, 0
  v_mov_b32 v59, 0
  v_mov_b32 v60, 0
  v_mov_b32 v61, 0
  v_mov_b32 v62, 0
  v_mov_b32 v63, 0
  v_mov_b32 v64, 0
  v_mov_b32 v65, 0
  v_mov_b32 v66, 0
  v_mov_b32 v67, 0
  v_mov_b32 v68, 0
  v_mov_b32 v69, 0
  v_mov_b32 v70, 0
  v_mov_b32 v71, 0
  v_cmp_gt_u32 vcc, 2, v2
  s_and_saveexec_b64 s[32:33], vcc
  global_load_dwordx4 v[40:43], v[72:73], off offset:0
  global_load_dwordx4 v[44:47], v[72:73], off offset:64
  global_load_dwordx4 v[48:51], v[72:73], off offset:128
  global_load_dwordx4 v[52:55], v[72:73], off offset:192
  global_load_dwordx4 v[56:59], v[72:73], off offset:256
  global_load_dwordx4 v[60:63], v[72:73], off offset:320
  global_load_dwordx4 v[64:67], v[72:73], off offset:384
  global_load_dwordx4 v[68:71], v[72:73], off offset:448
  s_mov_b64 exec, s[32:33]
  s_lshl_b32 s27, s2, 13
  v_lshlrev_b32 v76, 9, v2
  v_lshl_add_u32 v76, v3, 4, v76
  v_add_u32 v76, s27, v76
  global_load_dwordx4 v[8:11], v76, s[10:11] offset:0
  global_load_dwordx4 v[12:15], v76, s[10:11] offset:64
  global_load_dwordx4 v[16:19], v76, s[10:11] offset:128
  global_load_dwordx4 v[20:23], v76, s[10:11] offset:192
  global_load_dwordx4 v[24:27], v76, s[10:11] offset:256
  global_load_dwordx4 v[28:31], v76, s[10:11] offset:320
  global_load_dwordx4 v[32:35], v76, s[10:11] offset:384
  global_load_dwordx4 v[36:39], v76, s[10:11] offset:448
  s_branch KA_INIT
KA_SHUF_LOAD:
  s_mov_b32 s36, 2
  s_lshr_b32 s27, s2, 5
  s_lshl_b32 s27, s27, 6
  s_and_b32 s34, s2, 31
  s_lshl_b32 s34, s34, 14
  s_add_u32 s27, s27, s34
  s_sub_u32 s34, s24, 8
  s_lshl_b32 s34, s34, 3
  s_add_u32 s27, s27, s34
  v_lshrrev_b32 v76, 2, v2
  v_lshlrev_b32 v76, 4, v76
  v_and_b32 v77, 3, v2
  v_lshl_add_u32 v76, v77, 1, v76
  v_lshl_add_u32 v76, v3, 12, v76
  v_add_u32 v76, s27, v76
  global_load_ushort v44, v76, s[10:11] offset:0
  global_load_ushort v45, v76, s[10:11] offset:512
  global_load_ushort v46, v76, s[10:11] offset:1024
  global_load_ushort v47, v76, s[10:11] offset:1536
  global_load_ushort v48, v76, s[10:11] offset:2048
  global_load_ushort v49, v76, s[10:11] offset:2560
  global_load_ushort v50, v76, s[10:11] offset:3072
  global_load_ushort v51, v76, s[10:11] offset:3584
KA_INIT:
  s_min_u32 s27, s2, 249
  s_mul_i32 s27, s27, 20480
  s_lshl_b32 s34, s24, 11
  s_add_u32 s27, s27, s34
  v_lshl_add_u32 v88, v1, 4, s27
  v_mov_b32 v78, v88
  global_load_dwordx4 v[96:99], v88, s[4:5]
  global_load_dwordx4 v[100:103], v88, s[4:5] offset:1024
  v_mov_b32 v80, -1
  v_mov_b32 v84, 0
  v_mov_b32 v81, -1
  v_mov_b32 v85, 0
  v_mov_b32 v82, -1
  v_mov_b32 v86, 0
  v_mov_b32 v83, -1
  v_mov_b32 v87, 0
  v_lshlrev_b32 v79, 4, v0
  ds_write_b128 v79, v[80:83] offset:0
  v_cmp_gt_u32 vcc, 360, v0
  s_and_saveexec_b64 s[32:33], vcc
  ds_write_b128 v79, v[80:83] offset:10240
  s_mov_b64 exec, s[32:33]
  v_cmp_gt_u32 vcc, 64, v0
  s_and_saveexec_b64 s[32:33], vcc
  ds_write_b128 v79, v[84:87] offset:16000
  s_mov_b64 exec, s[32:33]
  s_waitcnt lgkmcnt(0)
  s_barrier
  s_cmp_ge_u32 s2, 250
  s_cbranch_scc1 KA_NOPART
  s_cmp_eq_u32 s36, 1
  s_cbranch_scc1 KA_PW1
  s_cmp_eq_u32 s36, 2
  s_cbranch_scc1 KA_PW2
  s_waitcnt vmcnt(2)
  s_branch KA_PW3
KA_PW1:
  s_waitcnt vmcnt(18)
  s_branch KA_PW3
KA_PW2:
  s_waitcnt vmcnt(10)
KA_PW3:
  v_mul_u32_u24 v6, 52429, v4
  v_lshrrev_b32 v6, 21, v6
  v_mul_u32_u24 v7, 40, v6
  v_sub_u32 v7, v4, v7
  v_lshl_or_b32 v7, v7, 16, v5
  v_lshlrev_b32 v88, 2, v6
  v_mov_b32 v89, 1
  ds_add_rtn_u32 v90, v88, v89 offset:16000
  v_mov_b32 v91, 0xfffffffe
  v_lshlrev_b32 v88, 6, v6
  s_waitcnt lgkmcnt(0)
  v_cmp_gt_u32 vcc, 15, v90
  v_min_u32 v90, 15, v90
  v_lshl_add_u32 v88, v90, 2, v88
  v_cndmask_b32 v7, v91, v7, vcc
  ds_write_b32 v88, v7 offset:0
KA_NOPART:
  s_waitcnt lgkmcnt(0)
  s_barrier
  s_cmp_ge_u32 s2, 250
  s_cbranch_scc1 KA_NOCOPY
  ds_read_b128 v[80:83], v79 offset:0
  ds_read_b128 v[84:87], v79 offset:10240
  v_lshrrev_b32 v88, 2, v0
  v_mul_u32_u24 v88, 16000, v88
  v_and_b32 v89, 3, v0
  v_lshl_add_u32 v88, v89, 4, v88
  s_lshl_b32 s27, s2, 6
  v_add_u32 v88, s27, v88
  v_add_u32 v89, 2560000, v88
  s_waitcnt lgkmcnt(0)
  global_store_dwordx4 v88, v[80:83], s[16:17]
  v_cmp_gt_u32 vcc, 360, v0
  s_and_saveexec_b64 s[32:33], vcc
  s_cbranch_execz KA_CP2
  global_store_dwordx4 v89, v[84:87], s[16:17]
KA_CP2:
  s_mov_b64 exec, s[32:33]
KA_NOCOPY:
  s_cmp_eq_u32 s36, 0
  s_cbranch_scc1 KA_FIN
  s_cmp_eq_u32 s36, 2
  s_cbranch_scc1 KA_SHUF_ST
  s_waitcnt vmcnt(0)
  v_mfma_f32_16x16x32_bf16 v[92:95], v[8:11], v[40:43], 0
  v_mfma_f32_16x16x32_bf16 v[92:95], v[12:15], v[44:47], v[92:95]
  v_mfma_f32_16x16x32_bf16 v[92:95], v[16:19], v[48:51], v[92:95]
  v_mfma_f32_16x16x32_bf16 v[92:95], v[20:23], v[52:55], v[92:95]
  v_mfma_f32_16x16x32_bf16 v[92:95], v[24:27], v[56:59], v[92:95]
  v_mfma_f32_16x16x32_bf16 v[92:95], v[28:31], v[60:63], v[92:95]
  v_mfma_f32_16x16x32_bf16 v[92:95], v[32:35], v[64:67], v[92:95]
  v_mfma_f32_16x16x32_bf16 v[92:95], v[36:39], v[68:71], v[92:95]
  s_lshr_b32 s27, s26, 1
  s_lshl_b32 s27, s27, 10
  s_and_b32 s34, s26, 1
  s_lshl_b32 s34, s34, 9
  s_add_u32 s27, s27, s34
  s_lshl_b32 s34, s25, 6
  s_add_u32 s27, s27, s34
  s_add_u32 s27, s27, 6291456
  v_lshrrev_b32 v88, 1, v3
  v_lshlrev_b32 v88, 8, v88
  v_lshl_add_u32 v88, v2, 5, v88
  v_and_b32 v89, 1, v3
  v_lshl_add_u32 v88, v89, 3, v88
  v_add_u32 v88, s27, v88
  s_mov_b32 s34, 0x3fb8aa3b
  s_mov_b32 s35, 0xffff0000
  v_cmp_gt_u32 vcc, 2, v2
  s_nop 1
  v_mul_f32 v92, s34, v92
  v_mul_f32 v93, s34, v93
  v_mul_f32 v94, s34, v94
  v_mul_f32 v95, s34, v95
  v_cvt_pk_bf16_f32 v80, v92, v93
  v_cvt_pk_bf16_f32 v81, v94, v95
  v_lshlrev_b32 v82, 16, v80
  v_and_b32 v83, s35, v80
  v_lshlrev_b32 v84, 16, v81
  v_and_b32 v85, s35, v81
  v_sub_f32 v82, v92, v82
  v_sub_f32 v83, v93, v83
  v_sub_f32 v84, v94, v84
  v_sub_f32 v85, v95, v85
  v_cvt_pk_bf16_f32 v82, v82, v83
  v_cvt_pk_bf16_f32 v83, v84, v85
  s_and_saveexec_b64 s[32:33], vcc
  global_store_dwordx2 v88, v[80:81], s[16:17]
  global_store_dwordx2 v88, v[82:83], s[16:17] offset:16
  s_mov_b64 exec, s[32:33]
  s_branch KA_FIN
KA_SHUF_ST:
  s_waitcnt vmcnt(0)
  v_lshl_or_b32 v40, v45, 16, v44
  v_lshl_or_b32 v41, v47, 16, v46
  v_lshl_or_b32 v42, v49, 16, v48
  v_lshl_or_b32 v43, v51, 16, v50
  s_lshl_b32 s27, s2, 11
  s_add_u32 s27, s27, 5234688
  v_lshl_add_u32 v88, v0, 4, s27
  global_store_dwordx4 v88, v[40:43], s[16:17]
KA_FIN:
KA_END:
  s_endpgm
.globl gat_main_kernel
.p2align 8
.type gat_main_kernel,@function
gat_main_kernel:
  s_cmp_ge_u32 s2, 250
  s_cbranch_scc1 KB_END
  s_load_dwordx4 s[4:7], s[0:1], 0
  s_load_dwordx2 s[8:9], s[0:1], 16
  s_load_dwordx2 s[12:13], s[0:1], 48
  s_load_dwordx2 s[14:15], s[0:1], 64
  v_lshrrev_b32 v6, 6, v0
  v_and_b32 v1, 63, v0
  v_and_b32 v2, 15, v1
  v_lshrrev_b32 v3, 4, v1
  v_readfirstlane_b32 s28, v6
  s_mul_i32 s29, s2, 40
  s_mov_b32 s30, 0x05040100
  s_mov_b32 s31, 0x07060302
  s_movk_i32 s32, 0x200
  s_mov_b32 s33, 0xfffffffe
  s_and_b32 s66, s2, 15
  v_lshlrev_b32 v4, 4, v0
  v_mov_b32 v12, -1
  v_mov_b32 v13, -1
  v_mov_b32 v14, -1
  v_mov_b32 v15, -1
  s_sub_u32 s50, s28, 4
  s_waitcnt lgkmcnt(0)
  s_mov_b32 s16, s4
  s_and_b32 s17, s5, 0xffff
  s_mov_b32 s18, 5120000
  s_mov_b32 s19, 0x20000
  s_cmp_ge_u32 s50, 3
  s_cbranch_scc1 KB_CELLS
  s_lshl_b32 s60, s50, 4
  s_add_u32 s60, s60, s29
  v_add_u32 v6, s60, v2
  v_lshlrev_b32 v6, 9, v6
  v_lshl_add_u32 v6, v3, 4, v6
  s_add_u32 s60, s14, 6291456
  s_addc_u32 s61, s15, 0
  v_lshlrev_b32 v7, 4, v1
  v_add_u32 v5, 0x1000, v7
  buffer_load_dwordx4 v[64:67], v6, s[16:19], 0 offen offset:0
  global_load_dwordx4 v[96:99], v7, s[60:61] offset:0
  buffer_load_dwordx4 v[68:71], v6, s[16:19], 0 offen offset:64
  global_load_dwordx4 v[100:103], v7, s[60:61] offset:1024
  buffer_load_dwordx4 v[72:75], v6, s[16:19], 0 offen offset:128
  global_load_dwordx4 v[104:107], v7, s[60:61] offset:2048
  buffer_load_dwordx4 v[76:79], v6, s[16:19], 0 offen offset:192
  global_load_dwordx4 v[108:111], v7, s[60:61] offset:3072
  buffer_load_dwordx4 v[80:83], v6, s[16:19], 0 offen offset:256
  global_load_dwordx4 v[112:115], v5, s[60:61] offset:0
  buffer_load_dwordx4 v[84:87], v6, s[16:19], 0 offen offset:320
  global_load_dwordx4 v[116:119], v5, s[60:61] offset:1024
  buffer_load_dwordx4 v[88:91], v6, s[16:19], 0 offen offset:384
  global_load_dwordx4 v[120:123], v5, s[60:61] offset:2048
  buffer_load_dwordx4 v[92:95], v6, s[16:19], 0 offen offset:448
  global_load_dwordx4 v[124:127], v5, s[60:61] offset:3072
KB_CELLS:
  s_mul_i32 s60, s2, 16000
  s_add_u32 s24, s14, s60
  s_addc_u32 s25, s15, 0
  v_add_u32 v5, 0x2000, v4
  global_load_dwordx4 v[8:11], v4, s[24:25]
  v_cmp_gt_u32 vcc, 488, v0
  s_and_saveexec_b64 s[34:35], vcc
  global_load_dwordx4 v[12:15], v5, s[24:25]
  s_mov_b64 exec, s[34:35]
  s_add_u32 s26, s14, 4194304
  s_addc_u32 s27, s15, 0
  s_and_b32 s60, s28, 3
  s_lshl_b32 s60, s60, 17
  s_add_u32 s60, s60, 5242880
  s_add_u32 s20, s14, s60
  s_addc_u32 s21, s15, 0
  s_and_b32 s21, s21, 0xffff
  s_mov_b32 s22, 131072
  s_mov_b32 s23, 0x20000
  v_mov_b32 v20, 0
  v_mov_b32 v24, -1
  v_mov_b32 v21, 0
  v_mov_b32 v25, -1
  v_mov_b32 v22, 0
  v_mov_b32 v26, -1
  v_mov_b32 v23, 0
  v_mov_b32 v27, -1
  v_add_u32 v5, 82560, v4
  ds_write_b128 v5, v[20:23] offset:0
  ds_write_b128 v5, v[20:23] offset:8192
  ds_write_b128 v5, v[20:23] offset:16384
  ds_write_b128 v5, v[20:23] offset:24576
  ds_write_b128 v5, v[20:23] offset:32768
  v_cmp_gt_u32 vcc, 160, v0
  s_and_saveexec_b64 s[34:35], vcc
  ds_write_b128 v5, v[20:23] offset:40960
  s_mov_b64 exec, s[34:35]
  v_add_u32 v5, 126080, v4
  v_cmp_gt_u32 vcc, 328, v0
  s_and_saveexec_b64 s[34:35], vcc
  ds_write_b128 v5, v[24:27]
  s_mov_b64 exec, s[34:35]
  v_add_u32 v5, 132864, v4
  v_cmp_gt_u32 vcc, 4, v0
  s_and_saveexec_b64 s[34:35], vcc
  ds_write_b128 v5, v[20:23]
  s_mov_b64 exec, s[34:35]
  s_cmp_ge_u32 s50, 3
  s_cbranch_scc1 KB_NOS
  s_waitcnt vmcnt(16)
  v_mfma_f32_16x16x32_bf16 v[28:31], v[64:67], v[96:99], 0
  s_waitcnt vmcnt(14)
  v_mfma_f32_16x16x32_bf16 v[28:31], v[68:71], v[100:103], v[28:31]
  s_waitcnt vmcnt(12)
  v_mfma_f32_16x16x32_bf16 v[28:31], v[72:75], v[104:107], v[28:31]
  s_waitcnt vmcnt(10)
  v_mfma_f32_16x16x32_bf16 v[28:31], v[76:79], v[108:111], v[28:31]
  s_waitcnt vmcnt(8)
  v_mfma_f32_16x16x32_bf16 v[28:31], v[80:83], v[112:115], v[28:31]
  s_waitcnt vmcnt(6)
  v_mfma_f32_16x16x32_bf16 v[28:31], v[84:87], v[116:119], v[28:31]
  s_waitcnt vmcnt(4)
  v_mfma_f32_16x16x32_bf16 v[28:31], v[88:91], v[120:123], v[28:31]
  s_waitcnt vmcnt(2)
  v_mfma_f32_16x16x32_bf16 v[28:31], v[92:95], v[124:127], v[28:31]
  s_lshl_b32 s60, s50, 9
  s_add_u32 s60, s60, 131328
  v_lshlrev_b32 v6, 7, v3
  v_bfe_u32 v7, v2, 1, 1
  v_lshl_add_u32 v6, v7, 4, v6
  v_lshrrev_b32 v7, 2, v2
  v_lshl_add_u32 v6, v7, 2, v6
  v_add_u32 v6, s60, v6
  v_lshl_add_u32 v16, v1, 5, s60
  s_lshl_b32 s61, s50, 4
  v_add_u32 v17, s61, v1
  v_add_u32 v18, s29, v17
  v_lshlrev_b32 v18, 4, v18
  v_and_b32 v7, 1, v2
  v_cmp_eq_u32 vcc, 0, v7
  v_cmp_gt_u32 s[42:43], 40, v17
  v_add_f32_dpp v32, v28, v28 quad_perm:[1,0,3,2] row_mask:0xf bank_mask:0xf
  v_add_f32_dpp v33, v29, v29 quad_perm:[1,0,3,2] row_mask:0xf bank_mask:0xf
  v_add_f32_dpp v34, v30, v30 quad_perm:[1,0,3,2] row_mask:0xf bank_mask:0xf
  v_add_f32_dpp v35, v31, v31 quad_perm:[1,0,3,2] row_mask:0xf bank_mask:0xf
  s_and_saveexec_b64 s[34:35], vcc
  ds_write_b32 v6, v32 offset:0
  ds_write_b32 v6, v33 offset:32
  ds_write_b32 v6, v34 offset:64
  ds_write_b32 v6, v35 offset:96
  s_and_b64 exec, s[42:43], 0xffff
  s_waitcnt lgkmcnt(0)
  ds_read_b128 v[32:35], v16
  s_waitcnt lgkmcnt(0)
  global_store_dwordx4 v18, v[32:35], s[26:27] sc1
  s_mov_b64 exec, -1
  s_waitcnt vmcnt(1)
  s_branch KB_B0
KB_NOS:
  s_waitcnt vmcnt(0)
KB_B0:
  s_waitcnt lgkmcnt(0)
  s_barrier
  s_mov_b64 s[34:35], 0
  v_mov_b32 v6, 1
  v_cmp_gt_u32 s[36:37], s33, v8
  v_cmp_eq_u32 vcc, s33, v8
  v_lshrrev_b32 v16, 18, v8
  s_or_b64 s[34:35], s[34:35], vcc
  v_lshlrev_b32 v7, 2, v16
  v_add_u32 v7, 132864, v7
  s_mov_b64 exec, s[36:37]
  ds_add_rtn_u32 v24, v7, v6
  s_mov_b64 exec, -1
  v_cmp_gt_u32 s[38:39], s33, v9
  v_cmp_eq_u32 vcc, s33, v9
  v_lshrrev_b32 v17, 18, v9
  s_or_b64 s[34:35], s[34:35], vcc
  v_lshlrev_b32 v7, 2, v17
  v_add_u32 v7, 132864, v7
  s_mov_b64 exec, s[38:39]
  ds_add_rtn_u32 v25, v7, v6
  s_mov_b64 exec, -1
  v_cmp_gt_u32 s[40:41], s33, v10
  v_cmp_eq_u32 vcc, s33, v10
  v_lshrrev_b32 v18, 18, v10
  s_or_b64 s[34:35], s[34:35], vcc
  v_lshlrev_b32 v7, 2, v18
  v_add_u32 v7, 132864, v7
  s_mov_b64 exec, s[40:41]
  ds_add_rtn_u32 v26, v7, v6
  s_mov_b64 exec, -1
  v_cmp_gt_u32 s[42:43], s33, v11
  v_cmp_eq_u32 vcc, s33, v11
  v_lshrrev_b32 v19, 18, v11
  s_or_b64 s[34:35], s[34:35], vcc
  v_lshlrev_b32 v7, 2, v19
  v_add_u32 v7, 132864, v7
  s_mov_b64 exec, s[42:43]
  ds_add_rtn_u32 v27, v7, v6
  s_mov_b64 exec, -1
  v_cmp_gt_u32 s[44:45], s33, v12
  v_cmp_eq_u32 vcc, s33, v12
  v_lshrrev_b32 v20, 18, v12
  s_or_b64 s[34:35], s[34:35], vcc
  v_lshlrev_b32 v7, 2, v20
  v_add_u32 v7, 132864, v7
  s_mov_b64 exec, s[44:45]
  ds_add_rtn_u32 v28, v7, v6
  s_mov_b64 exec, -1
  v_cmp_gt_u32 s[46:47], s33, v13
  v_cmp_eq_u32 vcc, s33, v13
  v_lshrrev_b32 v21, 18, v13
  s_or_b64 s[34:35], s[34:35], vcc
  v_lshlrev_b32 v7, 2, v21
  v_add_u32 v7, 132864, v7
  s_mov_b64 exec, s[46:47]
  ds_add_rtn_u32 v29, v7, v6
  s_mov_b64 exec, -1
  v_cmp_gt_u32 s[48:49], s33, v14
  v_cmp_eq_u32 vcc, s33, v14
  v_lshrrev_b32 v22, 18, v14
  s_or_b64 s[34:35], s[34:35], vcc
  v_lshlrev_b32 v7, 2, v22
  v_add_u32 v7, 132864, v7
  s_mov_b64 exec, s[48:49]
  ds_add_rtn_u32 v30, v7, v6
  s_mov_b64 exec, -1
  v_cmp_gt_u32 s[50:51], s33, v15
  v_cmp_eq_u32 vcc, s33, v15
  v_lshrrev_b32 v23, 18, v15
  s_or_b64 s[34:35], s[34:35], vcc
  v_lshlrev_b32 v7, 2, v23
  v_add_u32 v7, 132864, v7
  s_mov_b64 exec, s[50:51]
  ds_add_rtn_u32 v31, v7, v6
  s_mov_b64 exec, -1
  s_waitcnt lgkmcnt(0)
  s_mov_b64 exec, s[36:37]
  v_cmp_lt_u32 vcc, 127, v24
  v_min_u32 v24, 127, v24
  v_lshlrev_b32 v7, 9, v16
  s_or_b64 s[34:35], s[34:35], vcc
  v_lshl_add_u32 v7, v24, 2, v7
  v_add_u32 v7, 126080, v7
  ds_write_b32 v7, v8
  s_mov_b64 exec, s[38:39]
  v_cmp_lt_u32 vcc, 127, v25
  v_min_u32 v25, 127, v25
  v_lshlrev_b32 v7, 9, v17
  s_or_b64 s[34:35], s[34:35], vcc
  v_lshl_add_u32 v7, v25, 2, v7
  v_add_u32 v7, 126080, v7
  ds_write_b32 v7, v9
  s_mov_b64 exec, s[40:41]
  v_cmp_lt_u32 vcc, 127, v26
  v_min_u32 v26, 127, v26
  v_lshlrev_b32 v7, 9, v18
  s_or_b64 s[34:35], s[34:35], vcc
  v_lshl_add_u32 v7, v26, 2, v7
  v_add_u32 v7, 126080, v7
  ds_write_b32 v7, v10
  s_mov_b64 exec, s[42:43]
  v_cmp_lt_u32 vcc, 127, v27
  v_min_u32 v27, 127, v27
  v_lshlrev_b32 v7, 9, v19
  s_or_b64 s[34:35], s[34:35], vcc
  v_lshl_add_u32 v7, v27, 2, v7
  v_add_u32 v7, 126080, v7
  ds_write_b32 v7, v11
  s_mov_b64 exec, s[44:45]
  v_cmp_lt_u32 vcc, 127, v28
  v_min_u32 v28, 127, v28
  v_lshlrev_b32 v7, 9, v20
  s_or_b64 s[34:35], s[34:35], vcc
  v_lshl_add_u32 v7, v28, 2, v7
  v_add_u32 v7, 126080, v7
  ds_write_b32 v7, v12
  s_mov_b64 exec, s[46:47]
  v_cmp_lt_u32 vcc, 127, v29
  v_min_u32 v29, 127, v29
  v_lshlrev_b32 v7, 9, v21
  s_or_b64 s[34:35], s[34:35], vcc
  v_lshl_add_u32 v7, v29, 2, v7
  v_add_u32 v7, 126080, v7
  ds_write_b32 v7, v13
  s_mov_b64 exec, s[48:49]
  v_cmp_lt_u32 vcc, 127, v30
  v_min_u32 v30, 127, v30
  v_lshlrev_b32 v7, 9, v22
  s_or_b64 s[34:35], s[34:35], vcc
  v_lshl_add_u32 v7, v30, 2, v7
  v_add_u32 v7, 126080, v7
  ds_write_b32 v7, v14
  s_mov_b64 exec, s[50:51]
  v_cmp_lt_u32 vcc, 127, v31
  v_min_u32 v31, 127, v31
  v_lshlrev_b32 v7, 9, v23
  s_or_b64 s[34:35], s[34:35], vcc
  v_lshl_add_u32 v7, v31, 2, v7
  v_add_u32 v7, 126080, v7
  ds_write_b32 v7, v15
  s_mov_b64 exec, -1
  s_cmp_eq_u64 s[34:35], 0
  s_cbranch_scc1 KB_NOFLAG
  v_mov_b32 v7, 132912
  ds_write_b32 v7, v6
KB_NOFLAG:
  s_waitcnt lgkmcnt(0)
  s_barrier
  v_mov_b32 v7, 132864
  ds_read_b32 v28, v7 offset:48
  s_cmp_ge_u32 s28, 4
  s_cbranch_scc1 KB_MS
  ds_read_b128 v[16:19], v7
  ds_read_b128 v[20:23], v7 offset:16
  ds_read_b128 v[24:27], v7 offset:32
  s_waitcnt lgkmcnt(0)
  v_readfirstlane_b32 s51, v28
  v_readfirstlane_b32 s70, v16
  v_readfirstlane_b32 s71, v17
  v_readfirstlane_b32 s72, v18
  v_readfirstlane_b32 s73, v19
  v_readfirstlane_b32 s74, v20
  v_readfirstlane_b32 s75, v21
  v_readfirstlane_b32 s76, v22
  v_readfirstlane_b32 s77, v23
  v_readfirstlane_b32 s78, v24
  v_readfirstlane_b32 s79, v25
  s_cmp_lg_u32 s51, 0
  s_cbranch_scc1 KB_FALLBACK
  s_add_u32 s70, s70, 31
  s_lshr_b32 s70, s70, 5
  s_max_u32 s70, s70, 1
  s_add_u32 s71, s71, 31
  s_lshr_b32 s71, s71, 5
  s_max_u32 s71, s71, 1
  s_add_u32 s72, s72, 31
  s_lshr_b32 s72, s72, 5
  s_max_u32 s72, s72, 1
  s_add_u32 s73, s73, 31
  s_lshr_b32 s73, s73, 5
  s_max_u32 s73, s73, 1
  s_add_u32 s74, s74, 31
  s_lshr_b32 s74, s74, 5
  s_max_u32 s74, s74, 1
  s_add_u32 s75, s75, 31
  s_lshr_b32 s75, s75, 5
  s_max_u32 s75, s75, 1
  s_add_u32 s76, s76, 31
  s_lshr_b32 s76, s76, 5
  s_max_u32 s76, s76, 1
  s_add_u32 s77, s77, 31
  s_lshr_b32 s77, s77, 5
  s_max_u32 s77, s77, 1
  s_add_u32 s78, s78, 31
  s_lshr_b32 s78, s78, 5
  s_max_u32 s78, s78, 1
  s_add_u32 s79, s79, 31
  s_lshr_b32 s79, s79, 5
  s_max_u32 s79, s79, 1
  s_mov_b32 s48, s70
  s_lshl_b32 s61, s71, 4
  s_or_b32 s48, s48, s61
  s_lshl_b32 s61, s72, 8
  s_or_b32 s48, s48, s61
  s_lshl_b32 s61, s73, 12
  s_or_b32 s48, s48, s61
  s_lshl_b32 s61, s74, 16
  s_or_b32 s48, s48, s61
  s_lshl_b32 s61, s75, 20
  s_or_b32 s48, s48, s61
  s_lshl_b32 s61, s76, 24
  s_or_b32 s48, s48, s61
  s_lshl_b32 s61, s77, 28
  s_or_b32 s48, s48, s61
  s_lshl_b32 s61, s79, 4
  s_or_b32 s49, s78, s61
  v_lshlrev_b32 v244, 4, v2
  v_lshlrev_b32 v245, 5, v3
  s_lshl_b32 s44, s28, 9
  s_add_u32 s44, s44, 126080
  s_mov_b32 s64, 0
  s_mov_b32 s53, s70
  s_cmp_eq_u32 s28, 1
  s_cselect_b32 s53, s71, s53
  s_cmp_eq_u32 s28, 2
  s_cselect_b32 s53, s72, s53
  s_cmp_eq_u32 s28, 3
  s_cselect_b32 s53, s73, s53
  s_mov_b32 s52, 1
  s_cmp_eq_u32 s53, 0
  s_cbranch_scc1 IAO_0
IA_0:
  v_add_u32 v248, s44, v245
  ds_read_b128 v[224:227], v248
  ds_read_b128 v[228:231], v248 offset:16
  s_add_u32 s44, s44, 128
  s_sub_u32 s53, s53, 1
  s_waitcnt lgkmcnt(0)
  v_mad_u32_u16 v232, v224, s32, v244
  v_mad_u32_u16 v233, v225, s32, v244
  v_mad_u32_u16 v234, v226, s32, v244
  v_mad_u32_u16 v235, v227, s32, v244
  v_mad_u32_u16 v236, v228, s32, v244
  v_mad_u32_u16 v237, v229, s32, v244
  v_mad_u32_u16 v238, v230, s32, v244
  v_mad_u32_u16 v239, v231, s32, v244
  buffer_load_dwordx4 v[40:43], v232, s[16:19], s64 offen
  buffer_load_dwordx4 v[44:47], v233, s[16:19], s64 offen
  buffer_load_dwordx4 v[48:51], v234, s[16:19], s64 offen
  buffer_load_dwordx4 v[52:55], v235, s[16:19], s64 offen
  buffer_load_dwordx4 v[56:59], v236, s[16:19], s64 offen
  buffer_load_dwordx4 v[60:63], v237, s[16:19], s64 offen
  buffer_load_dwordx4 v[64:67], v238, s[16:19], s64 offen
  buffer_load_dwordx4 v[68:71], v239, s[16:19], s64 offen
  v_min_u32 v6, 4, v1
  v_lshl_add_u32 v8, v6, 2, s28
  s_mov_b32 s58, 5
  v_cmp_le_u32 vcc, 10, v8
  v_subrev_u32 v9, 10, v8
  v_mov_b32 v10, 0
  v_mov_b32 v11, 1
  v_cndmask_b32 v8, v8, v9, vcc
  v_cndmask_b32 v10, v10, v11, vcc
  v_lshlrev_b32 v6, 2, v8
  v_mov_b32 v12, s48
  v_mov_b32 v13, s49
  v_lshrrev_b64 v[12:13], v6, v[12:13]
  v_and_b32 v12, 15, v12
  v_lshlrev_b32 v13, 18, v12
  v_lshlrev_b32 v251, 9, v8
  v_add_u32 v251, 126080, v251
  v_or_b32 v251, v251, v13
  v_lshl_or_b32 v251, v10, 22, v251
  v_mul_u32_u24 v252, 4352, v8
  v_add_u32 v252, 82560, v252
  v_or_b32 v252, v252, v13
  v_mul_u32_u24 v253, 8256, v8
  v_lshl_add_u32 v253, v10, 8, v253
  v_lshl_or_b32 v253, v10, 20, v253
  v_cmp_gt_u32 vcc, s58, v1
  v_mov_b32 v6, 393344
  v_mov_b32 v7, 344704
  v_cndmask_b32 v251, v6, v251, vcc
  v_cndmask_b32 v252, v7, v252, vcc
  s_nop 1
  s_cmp_eq_u32 s53, 0
  s_cbranch_scc1 IAO_1
IA_1:
  v_add_u32 v248, s44, v245
  ds_read_b128 v[224:227], v248
  ds_read_b128 v[228:231], v248 offset:16
  s_add_u32 s44, s44, 128
  s_sub_u32 s53, s53, 1
  s_waitcnt lgkmcnt(0)
  v_mad_u32_u16 v232, v224, s32, v244
  v_mad_u32_u16 v233, v225, s32, v244
  v_mad_u32_u16 v234, v226, s32, v244
  v_mad_u32_u16 v235, v227, s32, v244
  v_mad_u32_u16 v236, v228, s32, v244
  v_mad_u32_u16 v237, v229, s32, v244
  v_mad_u32_u16 v238, v230, s32, v244
  v_mad_u32_u16 v239, v231, s32, v244
  buffer_load_dwordx4 v[72:75], v232, s[16:19], s64 offen
  buffer_load_dwordx4 v[76:79], v233, s[16:19], s64 offen
  buffer_load_dwordx4 v[80:83], v234, s[16:19], s64 offen
  buffer_load_dwordx4 v[84:87], v235, s[16:19], s64 offen
  buffer_load_dwordx4 v[88:91], v236, s[16:19], s64 offen
  buffer_load_dwordx4 v[92:95], v237, s[16:19], s64 offen
  buffer_load_dwordx4 v[96:99], v238, s[16:19], s64 offen
  buffer_load_dwordx4 v[100:103], v239, s[16:19], s64 offen
  s_cmp_eq_u32 s53, 0
  s_cbranch_scc1 IAO_2
IA_2:
  v_add_u32 v248, s44, v245
  ds_read_b128 v[224:227], v248
  ds_read_b128 v[228:231], v248 offset:16
  s_add_u32 s44, s44, 128
  s_sub_u32 s53, s53, 1
  s_waitcnt lgkmcnt(0)
  v_mad_u32_u16 v232, v224, s32, v244
  v_mad_u32_u16 v233, v225, s32, v244
  v_mad_u32_u16 v234, v226, s32, v244
  v_mad_u32_u16 v235, v227, s32, v244
  v_mad_u32_u16 v236, v228, s32, v244
  v_mad_u32_u16 v237, v229, s32, v244
  v_mad_u32_u16 v238, v230, s32, v244
  v_mad_u32_u16 v239, v231, s32, v244
  buffer_load_dwordx4 v[104:107], v232, s[16:19], s64 offen
  buffer_load_dwordx4 v[108:111], v233, s[16:19], s64 offen
  buffer_load_dwordx4 v[112:115], v234, s[16:19], s64 offen
  buffer_load_dwordx4 v[116:119], v235, s[16:19], s64 offen
  buffer_load_dwordx4 v[120:123], v236, s[16:19], s64 offen
  buffer_load_dwordx4 v[124:127], v237, s[16:19], s64 offen
  buffer_load_dwordx4 v[128:131], v238, s[16:19], s64 offen
  buffer_load_dwordx4 v[132:135], v239, s[16:19], s64 offen
  v_mul_u32_u24 v246, 272, v2
  v_lshl_add_u32 v246, v3, 4, v246
  v_mul_u32_u24 v247, 2064, v3
  v_add_u32 v247, v247, v244
  v_mov_b32 v250, 1
  s_mov_b32 s60, 0x3f803f80
  v_mov_b32 v240, s60
  v_mov_b32 v241, s60
  v_mov_b32 v242, s60
  v_mov_b32 v243, s60
  v_mov_b32 v6, 132904
KB_SDW:
  ds_read_b32 v7, v6
  s_waitcnt lgkmcnt(0)
  v_readfirstlane_b32 s60, v7
  s_cmp_ge_u32 s60, 4
  s_cbranch_scc1 KB_SDW_D
  s_sleep 1
  s_branch KB_SDW
KB_SDW_D:
  s_cmp_eq_u32 s53, 0
  s_cbranch_scc1 IAO_3
IA_3:
  v_add_u32 v248, s44, v245
  ds_read_b128 v[224:227], v248
  ds_read_b128 v[228:231], v248 offset:16
  s_add_u32 s44, s44, 128
  s_sub_u32 s53, s53, 1
  s_waitcnt lgkmcnt(0)
  v_mad_u32_u16 v232, v224, s32, v244
  v_mad_u32_u16 v233, v225, s32, v244
  v_mad_u32_u16 v234, v226, s32, v244
  v_mad_u32_u16 v235, v227, s32, v244
  v_mad_u32_u16 v236, v228, s32, v244
  v_mad_u32_u16 v237, v229, s32, v244
  v_mad_u32_u16 v238, v230, s32, v244
  v_mad_u32_u16 v239, v231, s32, v244
  buffer_load_dwordx4 v[136:139], v232, s[16:19], s64 offen
  buffer_load_dwordx4 v[140:143], v233, s[16:19], s64 offen
  buffer_load_dwordx4 v[144:147], v234, s[16:19], s64 offen
  buffer_load_dwordx4 v[148:151], v235, s[16:19], s64 offen
  buffer_load_dwordx4 v[152:155], v236, s[16:19], s64 offen
  buffer_load_dwordx4 v[156:159], v237, s[16:19], s64 offen
  buffer_load_dwordx4 v[160:163], v238, s[16:19], s64 offen
  buffer_load_dwordx4 v[164:167], v239, s[16:19], s64 offen
  s_cmp_eq_u32 s53, 0
  s_cbranch_scc1 IAO_4
IA_4:
  v_add_u32 v248, s44, v245
  ds_read_b128 v[224:227], v248
  ds_read_b128 v[228:231], v248 offset:16
  s_add_u32 s44, s44, 128
  s_sub_u32 s53, s53, 1
  s_mov_b32 s54, 0
  v_readlane_b32 s61, v252, s54
  v_readlane_b32 s42, v253, s54
  s_add_u32 s54, s54, 1
  s_min_u32 s54, s54, 63
  s_and_b32 s43, s61, 0x3ffff
  s_lshr_b32 s55, s61, 18
  s_mov_b32 s45, s42
  s_mov_b32 s41, 1
  s_mov_b32 s65, 0
  v_mov_b32 v6, 132908
KB_GSW:
  ds_read_b32 v7, v6
  s_waitcnt lgkmcnt(0)
  v_readfirstlane_b32 s60, v7
  s_cmp_ge_u32 s60, 4
  s_cbranch_scc1 KB_GSW_D
  s_sleep 1
  s_branch KB_GSW
KB_GSW_D:
  v_add_u32 v249, s43, v246
  ds_read_b128 v[220:223], v249
  s_setprio 2
KB_LOOP:
  s_sub_u32 s55, s55, 1
  s_add_u32 s43, s43, 64
  s_mov_b32 s40, 0
  s_cmp_eq_u32 s55, 0
  s_cbranch_scc1 KB_CNO0
KB_CN0:
  s_waitcnt vmcnt(24) lgkmcnt(0)
  v_add_u32 v249, s43, v246
  ds_read_b128 v[36:39], v249
  s_cmp_lg_u32 s41, 0
  s_cbranch_scc1 KB_CF0
  v_perm_b32 v204, v44, v40, s30
  v_perm_b32 v205, v52, v48, s30
  v_perm_b32 v206, v60, v56, s30
  v_perm_b32 v207, v68, v64, s30
  v_mfma_f32_16x16x32_bf16 v[200:203], v[220:223], v[240:243], v[200:203]
  v_perm_b32 v208, v44, v40, s31
  v_perm_b32 v209, v52, v48, s31
  v_perm_b32 v210, v60, v56, s31
  v_perm_b32 v211, v68, v64, s31
  v_mfma_f32_16x16x32_bf16 v[168:171], v[220:223], v[204:207], v[168:171]
  v_perm_b32 v212, v45, v41, s30
  v_perm_b32 v213, v53, v49, s30
  v_perm_b32 v214, v61, v57, s30
  v_perm_b32 v215, v69, v65, s30
  v_mfma_f32_16x16x32_bf16 v[172:175], v[220:223], v[208:211], v[172:175]
  v_perm_b32 v216, v45, v41, s31
  v_perm_b32 v217, v53, v49, s31
  v_perm_b32 v218, v61, v57, s31
  v_perm_b32 v219, v69, v65, s31
  v_mfma_f32_16x16x32_bf16 v[176:179], v[220:223], v[212:215], v[176:179]
  v_perm_b32 v204, v46, v42, s30
  v_perm_b32 v205, v54, v50, s30
  v_perm_b32 v206, v62, v58, s30
  v_perm_b32 v207, v70, v66, s30
  v_mfma_f32_16x16x32_bf16 v[180:183], v[220:223], v[216:219], v[180:183]
  v_perm_b32 v208, v46, v42, s31
  v_perm_b32 v209, v54, v50, s31
  v_perm_b32 v210, v62, v58, s31
  v_perm_b32 v211, v70, v66, s31
  v_mfma_f32_16x16x32_bf16 v[184:187], v[220:223], v[204:207], v[184:187]
  v_perm_b32 v212, v47, v43, s30
  v_perm_b32 v213, v55, v51, s30
  v_perm_b32 v214, v63, v59, s30
  v_perm_b32 v215, v71, v67, s30
  v_mfma_f32_16x16x32_bf16 v[188:191], v[220:223], v[208:211], v[188:191]
  v_perm_b32 v216, v47, v43, s31
  v_perm_b32 v217, v55, v51, s31
  v_perm_b32 v218, v63, v59, s31
  v_perm_b32 v219, v71, v67, s31
  v_mfma_f32_16x16x32_bf16 v[192:195], v[220:223], v[212:215], v[192:195]
  v_mad_u32_u16 v232, v224, s32, v244
  v_mad_u32_u16 v233, v225, s32, v244
  v_mfma_f32_16x16x32_bf16 v[196:199], v[220:223], v[216:219], v[196:199]
KB_CC0:
  v_mad_u32_u16 v234, v226, s32, v244
  v_mad_u32_u16 v235, v227, s32, v244
  v_mad_u32_u16 v236, v228, s32, v244
  v_mad_u32_u16 v237, v229, s32, v244
  v_mad_u32_u16 v238, v230, s32, v244
  v_mad_u32_u16 v239, v231, s32, v244
  buffer_load_dwordx4 v[40:43], v232, s[16:19], s64 offen
  buffer_load_dwordx4 v[44:47], v233, s[16:19], s64 offen
  buffer_load_dwordx4 v[48:51], v234, s[16:19], s64 offen
  buffer_load_dwordx4 v[52:55], v235, s[16:19], s64 offen
  buffer_load_dwordx4 v[56:59], v236, s[16:19], s64 offen
  buffer_load_dwordx4 v[60:63], v237, s[16:19], s64 offen
  buffer_load_dwordx4 v[64:67], v238, s[16:19], s64 offen
  buffer_load_dwordx4 v[68:71], v239, s[16:19], s64 offen
  s_cmp_eq_u32 s53, 0
  s_cbranch_scc1 IAO_5
IA_5:
  v_add_u32 v248, s44, v245
  ds_read_b128 v[224:227], v248
  ds_read_b128 v[228:231], v248 offset:16
  s_add_u32 s44, s44, 128
  s_sub_u32 s53, s53, 1
  s_mov_b32 s41, s40
  s_cmp_lg_u32 s40, 0
  s_cbranch_scc1 KB_FIN0
KB_NOFIN0:
  s_sub_u32 s55, s55, 1
  s_add_u32 s43, s43, 64
  s_mov_b32 s40, 0
  s_cmp_eq_u32 s55, 0
  s_cbranch_scc1 KB_CNO1
KB_CN1:
  s_waitcnt vmcnt(24) lgkmcnt(0)
  v_add_u32 v249, s43, v246
  ds_read_b128 v[220:223], v249
  s_cmp_lg_u32 s41, 0
  s_cbranch_scc1 KB_CF1
  v_perm_b32 v204, v76, v72, s30
  v_perm_b32 v205, v84, v80, s30
  v_perm_b32 v206, v92, v88, s30
  v_perm_b32 v207, v100, v96, s30
  v_mfma_f32_16x16x32_bf16 v[200:203], v[36:39], v[240:243], v[200:203]
  v_perm_b32 v208, v76, v72, s31
  v_perm_b32 v209, v84, v80, s31
  v_perm_b32 v210, v92, v88, s31
  v_perm_b32 v211, v100, v96, s31
  v_mfma_f32_16x16x32_bf16 v[168:171], v[36:39], v[204:207], v[168:171]
  v_perm_b32 v212, v77, v73, s30
  v_perm_b32 v213, v85, v81, s30
  v_perm_b32 v214, v93, v89, s30
  v_perm_b32 v215, v101, v97, s30
  v_mfma_f32_16x16x32_bf16 v[172:175], v[36:39], v[208:211], v[172:175]
  v_perm_b32 v216, v77, v73, s31
  v_perm_b32 v217, v85, v81, s31
  v_perm_b32 v218, v93, v89, s31
  v_perm_b32 v219, v101, v97, s31
  v_mfma_f32_16x16x32_bf16 v[176:179], v[36:39], v[212:215], v[176:179]
  v_perm_b32 v204, v78, v74, s30
  v_perm_b32 v205, v86, v82, s30
  v_perm_b32 v206, v94, v90, s30
  v_perm_b32 v207, v102, v98, s30
  v_mfma_f32_16x16x32_bf16 v[180:183], v[36:39], v[216:219], v[180:183]
  v_perm_b32 v208, v78, v74, s31
  v_perm_b32 v209, v86, v82, s31
  v_perm_b32 v210, v94, v90, s31
  v_perm_b32 v211, v102, v98, s31
  v_mfma_f32_16x16x32_bf16 v[184:187], v[36:39], v[204:207], v[184:187]
  v_perm_b32 v212, v79, v75, s30
  v_perm_b32 v213, v87, v83, s30
  v_perm_b32 v214, v95, v91, s30
  v_perm_b32 v215, v103, v99, s30
  v_mfma_f32_16x16x32_bf16 v[188:191], v[36:39], v[208:211], v[188:191]
  v_perm_b32 v216, v79, v75, s31
  v_perm_b32 v217, v87, v83, s31
  v_perm_b32 v218, v95, v91, s31
  v_perm_b32 v219, v103, v99, s31
  v_mfma_f32_16x16x32_bf16 v[192:195], v[36:39], v[212:215], v[192:195]
  v_mad_u32_u16 v232, v224, s32, v244
  v_mad_u32_u16 v233, v225, s32, v244
  v_mfma_f32_16x16x32_bf16 v[196:199], v[36:39], v[216:219], v[196:199]
KB_CC1:
  v_mad_u32_u16 v234, v226, s32, v244
  v_mad_u32_u16 v235, v227, s32, v244
  v_mad_u32_u16 v236, v228, s32, v244
  v_mad_u32_u16 v237, v229, s32, v244
  v_mad_u32_u16 v238, v230, s32, v244
  v_mad_u32_u16 v239, v231, s32, v244
  buffer_load_dwordx4 v[72:75], v232, s[16:19], s64 offen
  buffer_load_dwordx4 v[76:79], v233, s[16:19], s64 offen
  buffer_load_dwordx4 v[80:83], v234, s[16:19], s64 offen
  buffer_load_dwordx4 v[84:87], v235, s[16:19], s64 offen
  buffer_load_dwordx4 v[88:91], v236, s[16:19], s64 offen
  buffer_load_dwordx4 v[92:95], v237, s[16:19], s64 offen
  buffer_load_dwordx4 v[96:99], v238, s[16:19], s64 offen
  buffer_load_dwordx4 v[100:103], v239, s[16:19], s64 offen
  s_cmp_eq_u32 s53, 0
  s_cbranch_scc1 IAO_6
IA_6:
  v_add_u32 v248, s44, v245
  ds_read_b128 v[224:227], v248
  ds_read_b128 v[228:231], v248 offset:16
  s_add_u32 s44, s44, 128
  s_sub_u32 s53, s53, 1
  s_mov_b32 s41, s40
  s_cmp_lg_u32 s40, 0
  s_cbranch_scc1 KB_FIN1
KB_NOFIN1:
  s_sub_u32 s55, s55, 1
  s_add_u32 s43, s43, 64
  s_mov_b32 s40, 0
  s_cmp_eq_u32 s55, 0
  s_cbranch_scc1 KB_CNO2
KB_CN2:
  s_waitcnt vmcnt(24) lgkmcnt(0)
  v_add_u32 v249, s43, v246
  ds_read_b128 v[36:39], v249
  s_cmp_lg_u32 s41, 0
  s_cbranch_scc1 KB_CF2
  v_perm_b32 v204, v108, v104, s30
  v_perm_b32 v205, v116, v112, s30
  v_perm_b32 v206, v124, v120, s30
  v_perm_b32 v207, v132, v128, s30
  v_mfma_f32_16x16x32_bf16 v[200:203], v[220:223], v[240:243], v[200:203]
  v_perm_b32 v208, v108, v104, s31
  v_perm_b32 v209, v116, v112, s31
  v_perm_b32 v210, v124, v120, s31
  v_perm_b32 v211, v132, v128, s31
  v_mfma_f32_16x16x32_bf16 v[168:171], v[220:223], v[204:207], v[168:171]
  v_perm_b32 v212, v109, v105, s30
  v_perm_b32 v213, v117, v113, s30
  v_perm_b32 v214, v125, v121, s30
  v_perm_b32 v215, v133, v129, s30
  v_mfma_f32_16x16x32_bf16 v[172:175], v[220:223], v[208:211], v[172:175]
  v_perm_b32 v216, v109, v105, s31
  v_perm_b32 v217, v117, v113, s31
  v_perm_b32 v218, v125, v121, s31
  v_perm_b32 v219, v133, v129, s31
  v_mfma_f32_16x16x32_bf16 v[176:179], v[220:223], v[212:215], v[176:179]
  v_perm_b32 v204, v110, v106, s30
  v_perm_b32 v205, v118, v114, s30
  v_perm_b32 v206, v126, v122, s30
  v_perm_b32 v207, v134, v130, s30
  v_mfma_f32_16x16x32_bf16 v[180:183], v[220:223], v[216:219], v[180:183]
  v_perm_b32 v208, v110, v106, s31
  v_perm_b32 v209, v118, v114, s31
  v_perm_b32 v210, v126, v122, s31
  v_perm_b32 v211, v134, v130, s31
  v_mfma_f32_16x16x32_bf16 v[184:187], v[220:223], v[204:207], v[184:187]
  v_perm_b32 v212, v111, v107, s30
  v_perm_b32 v213, v119, v115, s30
  v_perm_b32 v214, v127, v123, s30
  v_perm_b32 v215, v135, v131, s30
  v_mfma_f32_16x16x32_bf16 v[188:191], v[220:223], v[208:211], v[188:191]
  v_perm_b32 v216, v111, v107, s31
  v_perm_b32 v217, v119, v115, s31
  v_perm_b32 v218, v127, v123, s31
  v_perm_b32 v219, v135, v131, s31
  v_mfma_f32_16x16x32_bf16 v[192:195], v[220:223], v[212:215], v[192:195]
  v_mad_u32_u16 v232, v224, s32, v244
  v_mad_u32_u16 v233, v225, s32, v244
  v_mfma_f32_16x16x32_bf16 v[196:199], v[220:223], v[216:219], v[196:199]
KB_CC2:
  v_mad_u32_u16 v234, v226, s32, v244
  v_mad_u32_u16 v235, v227, s32, v244
  v_mad_u32_u16 v236, v228, s32, v244
  v_mad_u32_u16 v237, v229, s32, v244
  v_mad_u32_u16 v238, v230, s32, v244
  v_mad_u32_u16 v239, v231, s32, v244
  buffer_load_dwordx4 v[104:107], v232, s[16:19], s64 offen
  buffer_load_dwordx4 v[108:111], v233, s[16:19], s64 offen
  buffer_load_dwordx4 v[112:115], v234, s[16:19], s64 offen
  buffer_load_dwordx4 v[116:119], v235, s[16:19], s64 offen
  buffer_load_dwordx4 v[120:123], v236, s[16:19], s64 offen
  buffer_load_dwordx4 v[124:127], v237, s[16:19], s64 offen
  buffer_load_dwordx4 v[128:131], v238, s[16:19], s64 offen
  buffer_load_dwordx4 v[132:135], v239, s[16:19], s64 offen
  s_cmp_eq_u32 s53, 0
  s_cbranch_scc1 IAO_7
IA_7:
  v_add_u32 v248, s44, v245
  ds_read_b128 v[224:227], v248
  ds_read_b128 v[228:231], v248 offset:16
  s_add_u32 s44, s44, 128
  s_sub_u32 s53, s53, 1
  s_mov_b32 s41, s40
  s_cmp_lg_u32 s40, 0
  s_cbranch_scc1 KB_FIN2
KB_NOFIN2:
  s_sub_u32 s55, s55, 1
  s_add_u32 s43, s43, 64
  s_mov_b32 s40, 0
  s_cmp_eq_u32 s55, 0
  s_cbranch_scc1 KB_CNO3
KB_CN3:
  s_waitcnt vmcnt(24) lgkmcnt(0)
  v_add_u32 v249, s43, v246
  ds_read_b128 v[220:223], v249
  s_cmp_lg_u32 s41, 0
  s_cbranch_scc1 KB_CF3
  v_perm_b32 v204, v140, v136, s30
  v_perm_b32 v205, v148, v144, s30
  v_perm_b32 v206, v156, v152, s30
  v_perm_b32 v207, v164, v160, s30
  v_mfma_f32_16x16x32_bf16 v[200:203], v[36:39], v[240:243], v[200:203]
  v_perm_b32 v208, v140, v136, s31
  v_perm_b32 v209, v148, v144, s31
  v_perm_b32 v210, v156, v152, s31
  v_perm_b32 v211, v164, v160, s31
  v_mfma_f32_16x16x32_bf16 v[168:171], v[36:39], v[204:207], v[168:171]
  v_perm_b32 v212, v141, v137, s30
  v_perm_b32 v213, v149, v145, s30
  v_perm_b32 v214, v157, v153, s30
  v_perm_b32 v215, v165, v161, s30
  v_mfma_f32_16x16x32_bf16 v[172:175], v[36:39], v[208:211], v[172:175]
  v_perm_b32 v216, v141, v137, s31
  v_perm_b32 v217, v149, v145, s31
  v_perm_b32 v218, v157, v153, s31
  v_perm_b32 v219, v165, v161, s31
  v_mfma_f32_16x16x32_bf16 v[176:179], v[36:39], v[212:215], v[176:179]
  v_perm_b32 v204, v142, v138, s30
  v_perm_b32 v205, v150, v146, s30
  v_perm_b32 v206, v158, v154, s30
  v_perm_b32 v207, v166, v162, s30
  v_mfma_f32_16x16x32_bf16 v[180:183], v[36:39], v[216:219], v[180:183]
  v_perm_b32 v208, v142, v138, s31
  v_perm_b32 v209, v150, v146, s31
  v_perm_b32 v210, v158, v154, s31
  v_perm_b32 v211, v166, v162, s31
  v_mfma_f32_16x16x32_bf16 v[184:187], v[36:39], v[204:207], v[184:187]
  v_perm_b32 v212, v143, v139, s30
  v_perm_b32 v213, v151, v147, s30
  v_perm_b32 v214, v159, v155, s30
  v_perm_b32 v215, v167, v163, s30
  v_mfma_f32_16x16x32_bf16 v[188:191], v[36:39], v[208:211], v[188:191]
  v_perm_b32 v216, v143, v139, s31
  v_perm_b32 v217, v151, v147, s31
  v_perm_b32 v218, v159, v155, s31
  v_perm_b32 v219, v167, v163, s31
  v_mfma_f32_16x16x32_bf16 v[192:195], v[36:39], v[212:215], v[192:195]
  v_mad_u32_u16 v232, v224, s32, v244
  v_mad_u32_u16 v233, v225, s32, v244
  v_mfma_f32_16x16x32_bf16 v[196:199], v[36:39], v[216:219], v[196:199]
KB_CC3:
  v_mad_u32_u16 v234, v226, s32, v244
  v_mad_u32_u16 v235, v227, s32, v244
  v_mad_u32_u16 v236, v228, s32, v244
  v_mad_u32_u16 v237, v229, s32, v244
  v_mad_u32_u16 v238, v230, s32, v244
  v_mad_u32_u16 v239, v231, s32, v244
  buffer_load_dwordx4 v[136:139], v232, s[16:19], s64 offen
  buffer_load_dwordx4 v[140:143], v233, s[16:19], s64 offen
  buffer_load_dwordx4 v[144:147], v234, s[16:19], s64 offen
  buffer_load_dwordx4 v[148:151], v235, s[16:19], s64 offen
  buffer_load_dwordx4 v[152:155], v236, s[16:19], s64 offen
  buffer_load_dwordx4 v[156:159], v237, s[16:19], s64 offen
  buffer_load_dwordx4 v[160:163], v238, s[16:19], s64 offen
  buffer_load_dwordx4 v[164:167], v239, s[16:19], s64 offen
  s_cmp_eq_u32 s53, 0
  s_cbranch_scc1 IAO_8
IA_8:
  v_add_u32 v248, s44, v245
  ds_read_b128 v[224:227], v248
  ds_read_b128 v[228:231], v248 offset:16
  s_add_u32 s44, s44, 128
  s_sub_u32 s53, s53, 1
  s_mov_b32 s41, s40
  s_cmp_lg_u32 s40, 0
  s_cbranch_scc1 KB_FIN3
KB_NOFIN3:
  s_branch KB_LOOP
KB_GEND:
  s_waitcnt lgkmcnt(0)
KB_GDONE:
  s_endpgm
IAO_0:
  v_readlane_b32 s61, v251, s52
  s_add_u32 s52, s52, 1
  s_min_u32 s52, s52, 63
  s_and_b32 s44, s61, 0x3ffff
  s_bfe_u32 s53, s61, 0x40012
  s_lshr_b32 s64, s61, 14
  s_and_b32 s64, s64, 0x100
  s_branch IA_0
IAO_1:
  v_readlane_b32 s61, v251, s52
  s_add_u32 s52, s52, 1
  s_min_u32 s52, s52, 63
  s_and_b32 s44, s61, 0x3ffff
  s_bfe_u32 s53, s61, 0x40012
  s_lshr_b32 s64, s61, 14
  s_and_b32 s64, s64, 0x100
  s_branch IA_1
IAO_2:
  v_readlane_b32 s61, v251, s52
  s_add_u32 s52, s52, 1
  s_min_u32 s52, s52, 63
  s_and_b32 s44, s61, 0x3ffff
  s_bfe_u32 s53, s61, 0x40012
  s_lshr_b32 s64, s61, 14
  s_and_b32 s64, s64, 0x100
  s_branch IA_2
IAO_3:
  v_readlane_b32 s61, v251, s52
  s_add_u32 s52, s52, 1
  s_min_u32 s52, s52, 63
  s_and_b32 s44, s61, 0x3ffff
  s_bfe_u32 s53, s61, 0x40012
  s_lshr_b32 s64, s61, 14
  s_and_b32 s64, s64, 0x100
  s_branch IA_3
IAO_4:
  v_readlane_b32 s61, v251, s52
  s_add_u32 s52, s52, 1
  s_min_u32 s52, s52, 63
  s_and_b32 s44, s61, 0x3ffff
  s_bfe_u32 s53, s61, 0x40012
  s_lshr_b32 s64, s61, 14
  s_and_b32 s64, s64, 0x100
  s_branch IA_4
KB_CNO0:
  v_readlane_b32 s61, v252, s54
  v_readlane_b32 s42, v253, s54
  s_add_u32 s54, s54, 1
  s_min_u32 s54, s54, 63
  s_and_b32 s43, s61, 0x3ffff
  s_lshr_b32 s55, s61, 18
  s_mov_b32 s40, 1
  s_branch KB_CN0
KB_CF0:
  v_perm_b32 v204, v44, v40, s30
  v_perm_b32 v205, v52, v48, s30
  v_perm_b32 v206, v60, v56, s30
  v_perm_b32 v207, v68, v64, s30
  v_mfma_f32_16x16x32_bf16 v[200:203], v[220:223], v[240:243], 0
  v_perm_b32 v208, v44, v40, s31
  v_perm_b32 v209, v52, v48, s31
  v_perm_b32 v210, v60, v56, s31
  v_perm_b32 v211, v68, v64, s31
  v_mfma_f32_16x16x32_bf16 v[168:171], v[220:223], v[204:207], 0
  v_perm_b32 v212, v45, v41, s30
  v_perm_b32 v213, v53, v49, s30
  v_perm_b32 v214, v61, v57, s30
  v_perm_b32 v215, v69, v65, s30
  v_mfma_f32_16x16x32_bf16 v[172:175], v[220:223], v[208:211], 0
  v_perm_b32 v216, v45, v41, s31
  v_perm_b32 v217, v53, v49, s31
  v_perm_b32 v218, v61, v57, s31
  v_perm_b32 v219, v69, v65, s31
  v_mfma_f32_16x16x32_bf16 v[176:179], v[220:223], v[212:215], 0
  v_perm_b32 v204, v46, v42, s30
  v_perm_b32 v205, v54, v50, s30
  v_perm_b32 v206, v62, v58, s30
  v_perm_b32 v207, v70, v66, s30
  v_mfma_f32_16x16x32_bf16 v[180:183], v[220:223], v[216:219], 0
  v_perm_b32 v208, v46, v42, s31
  v_perm_b32 v209, v54, v50, s31
  v_perm_b32 v210, v62, v58, s31
  v_perm_b32 v211, v70, v66, s31
  v_mfma_f32_16x16x32_bf16 v[184:187], v[220:223], v[204:207], 0
  v_perm_b32 v212, v47, v43, s30
  v_perm_b32 v213, v55, v51, s30
  v_perm_b32 v214, v63, v59, s30
  v_perm_b32 v215, v71, v67, s30
  v_mfma_f32_16x16x32_bf16 v[188:191], v[220:223], v[208:211], 0
  v_perm_b32 v216, v47, v43, s31
  v_perm_b32 v217, v55, v51, s31
  v_perm_b32 v218, v63, v59, s31
  v_perm_b32 v219, v71, v67, s31
  v_mfma_f32_16x16x32_bf16 v[192:195], v[220:223], v[212:215], 0
  v_mad_u32_u16 v232, v224, s32, v244
  v_mad_u32_u16 v233, v225, s32, v244
  v_mfma_f32_16x16x32_bf16 v[196:199], v[220:223], v[216:219], 0
  s_branch KB_CC0
IAO_5:
  v_readlane_b32 s61, v251, s52
  s_add_u32 s52, s52, 1
  s_min_u32 s52, s52, 63
  s_and_b32 s44, s61, 0x3ffff
  s_bfe_u32 s53, s61, 0x40012
  s_lshr_b32 s64, s61, 14
  s_and_b32 s64, s64, 0x100
  s_branch IA_5
KB_FIN0:
  s_and_b32 s60, s45, 0xfffff
  v_add_u32 v249, s60, v247
  s_mov_b32 s61, 0x3089705f
  v_add_f32 v200, s61, v200
  v_add_f32 v201, s61, v201
  v_add_f32 v202, s61, v202
  v_add_f32 v203, s61, v203
  v_rcp_f32 v200, v200
  v_rcp_f32 v201, v201
  v_rcp_f32 v202, v202
  v_rcp_f32 v203, v203
  s_lshr_b32 s65, s45, 20
  s_lshl_b32 s65, s65, 2
  s_add_u32 s65, s65, 132916
  v_mul_f32 v200, 0.25, v200
  v_mul_f32 v201, 0.25, v201
  v_mul_f32 v202, 0.25, v202
  v_mul_f32 v203, 0.25, v203
  v_pk_mul_f32 v[168:169], v[168:169], v[200:201]
  v_pk_mul_f32 v[170:171], v[170:171], v[202:203]
  v_pk_mul_f32 v[172:173], v[172:173], v[200:201]
  v_pk_mul_f32 v[174:175], v[174:175], v[202:203]
  v_pk_mul_f32 v[176:177], v[176:177], v[200:201]
  v_pk_mul_f32 v[178:179], v[178:179], v[202:203]
  v_pk_mul_f32 v[180:181], v[180:181], v[200:201]
  v_pk_mul_f32 v[182:183], v[182:183], v[202:203]
  v_pk_mul_f32 v[184:185], v[184:185], v[200:201]
  v_pk_mul_f32 v[186:187], v[186:187], v[202:203]
  v_pk_mul_f32 v[188:189], v[188:189], v[200:201]
  v_pk_mul_f32 v[190:191], v[190:191], v[202:203]
  v_pk_mul_f32 v[192:193], v[192:193], v[200:201]
  v_pk_mul_f32 v[194:195], v[194:195], v[202:203]
  v_pk_mul_f32 v[196:197], v[196:197], v[200:201]
  v_pk_mul_f32 v[198:199], v[198:199], v[202:203]
  v_cvt_pk_bf16_f32 v204, v168, v172
  v_cvt_pk_bf16_f32 v205, v176, v180
  v_cvt_pk_bf16_f32 v206, v184, v188
  v_cvt_pk_bf16_f32 v207, v192, v196
  ds_write_b128 v249, v[204:207] offset:0
  v_cvt_pk_bf16_f32 v208, v169, v173
  v_cvt_pk_bf16_f32 v209, v177, v181
  v_cvt_pk_bf16_f32 v210, v185, v189
  v_cvt_pk_bf16_f32 v211, v193, v197
  ds_write_b128 v249, v[208:211] offset:512
  v_cvt_pk_bf16_f32 v212, v170, v174
  v_cvt_pk_bf16_f32 v213, v178, v182
  v_cvt_pk_bf16_f32 v214, v186, v190
  v_cvt_pk_bf16_f32 v215, v194, v198
  ds_write_b128 v249, v[212:215] offset:1024
  v_cvt_pk_bf16_f32 v216, v171, v175
  v_cvt_pk_bf16_f32 v217, v179, v183
  v_cvt_pk_bf16_f32 v218, v187, v191
  v_cvt_pk_bf16_f32 v219, v195, v199
  ds_write_b128 v249, v[216:219] offset:1536
  v_mov_b32 v249, s65
  s_mov_b32 s65, 0
  s_waitcnt lgkmcnt(0)
  s_mov_b64 exec, 1
  ds_add_u32 v249, v250
  s_mov_b64 exec, -1
  s_mov_b32 s45, s42
  s_cmp_ge_u32 s54, 6
  s_cbranch_scc1 KB_GEND
  s_branch KB_NOFIN0
KB_CNO1:
  v_readlane_b32 s61, v252, s54
  v_readlane_b32 s42, v253, s54
  s_add_u32 s54, s54, 1
  s_min_u32 s54, s54, 63
  s_and_b32 s43, s61, 0x3ffff
  s_lshr_b32 s55, s61, 18
  s_mov_b32 s40, 1
  s_branch KB_CN1
KB_CF1:
  v_perm_b32 v204, v76, v72, s30
  v_perm_b32 v205, v84, v80, s30
  v_perm_b32 v206, v92, v88, s30
  v_perm_b32 v207, v100, v96, s30
  v_mfma_f32_16x16x32_bf16 v[200:203], v[36:39], v[240:243], 0
  v_perm_b32 v208, v76, v72, s31
  v_perm_b32 v209, v84, v80, s31
  v_perm_b32 v210, v92, v88, s31
  v_perm_b32 v211, v100, v96, s31
  v_mfma_f32_16x16x32_bf16 v[168:171], v[36:39], v[204:207], 0
  v_perm_b32 v212, v77, v73, s30
  v_perm_b32 v213, v85, v81, s30
  v_perm_b32 v214, v93, v89, s30
  v_perm_b32 v215, v101, v97, s30
  v_mfma_f32_16x16x32_bf16 v[172:175], v[36:39], v[208:211], 0
  v_perm_b32 v216, v77, v73, s31
  v_perm_b32 v217, v85, v81, s31
  v_perm_b32 v218, v93, v89, s31
  v_perm_b32 v219, v101, v97, s31
  v_mfma_f32_16x16x32_bf16 v[176:179], v[36:39], v[212:215], 0
  v_perm_b32 v204, v78, v74, s30
  v_perm_b32 v205, v86, v82, s30
  v_perm_b32 v206, v94, v90, s30
  v_perm_b32 v207, v102, v98, s30
  v_mfma_f32_16x16x32_bf16 v[180:183], v[36:39], v[216:219], 0
  v_perm_b32 v208, v78, v74, s31
  v_perm_b32 v209, v86, v82, s31
  v_perm_b32 v210, v94, v90, s31
  v_perm_b32 v211, v102, v98, s31
  v_mfma_f32_16x16x32_bf16 v[184:187], v[36:39], v[204:207], 0
  v_perm_b32 v212, v79, v75, s30
  v_perm_b32 v213, v87, v83, s30
  v_perm_b32 v214, v95, v91, s30
  v_perm_b32 v215, v103, v99, s30
  v_mfma_f32_16x16x32_bf16 v[188:191], v[36:39], v[208:211], 0
  v_perm_b32 v216, v79, v75, s31
  v_perm_b32 v217, v87, v83, s31
  v_perm_b32 v218, v95, v91, s31
  v_perm_b32 v219, v103, v99, s31
  v_mfma_f32_16x16x32_bf16 v[192:195], v[36:39], v[212:215], 0
  v_mad_u32_u16 v232, v224, s32, v244
  v_mad_u32_u16 v233, v225, s32, v244
  v_mfma_f32_16x16x32_bf16 v[196:199], v[36:39], v[216:219], 0
  s_branch KB_CC1
IAO_6:
  v_readlane_b32 s61, v251, s52
  s_add_u32 s52, s52, 1
  s_min_u32 s52, s52, 63
  s_and_b32 s44, s61, 0x3ffff
  s_bfe_u32 s53, s61, 0x40012
  s_lshr_b32 s64, s61, 14
  s_and_b32 s64, s64, 0x100
  s_branch IA_6
KB_FIN1:
  s_and_b32 s60, s45, 0xfffff
  v_add_u32 v249, s60, v247
  s_mov_b32 s61, 0x3089705f
  v_add_f32 v200, s61, v200
  v_add_f32 v201, s61, v201
  v_add_f32 v202, s61, v202
  v_add_f32 v203, s61, v203
  v_rcp_f32 v200, v200
  v_rcp_f32 v201, v201
  v_rcp_f32 v202, v202
  v_rcp_f32 v203, v203
  s_lshr_b32 s65, s45, 20
  s_lshl_b32 s65, s65, 2
  s_add_u32 s65, s65, 132916
  v_mul_f32 v200, 0.25, v200
  v_mul_f32 v201, 0.25, v201
  v_mul_f32 v202, 0.25, v202
  v_mul_f32 v203, 0.25, v203
  v_pk_mul_f32 v[168:169], v[168:169], v[200:201]
  v_pk_mul_f32 v[170:171], v[170:171], v[202:203]
  v_pk_mul_f32 v[172:173], v[172:173], v[200:201]
  v_pk_mul_f32 v[174:175], v[174:175], v[202:203]
  v_pk_mul_f32 v[176:177], v[176:177], v[200:201]
  v_pk_mul_f32 v[178:179], v[178:179], v[202:203]
  v_pk_mul_f32 v[180:181], v[180:181], v[200:201]
  v_pk_mul_f32 v[182:183], v[182:183], v[202:203]
  v_pk_mul_f32 v[184:185], v[184:185], v[200:201]
  v_pk_mul_f32 v[186:187], v[186:187], v[202:203]
  v_pk_mul_f32 v[188:189], v[188:189], v[200:201]
  v_pk_mul_f32 v[190:191], v[190:191], v[202:203]
  v_pk_mul_f32 v[192:193], v[192:193], v[200:201]
  v_pk_mul_f32 v[194:195], v[194:195], v[202:203]
  v_pk_mul_f32 v[196:197], v[196:197], v[200:201]
  v_pk_mul_f32 v[198:199], v[198:199], v[202:203]
  v_cvt_pk_bf16_f32 v204, v168, v172
  v_cvt_pk_bf16_f32 v205, v176, v180
  v_cvt_pk_bf16_f32 v206, v184, v188
  v_cvt_pk_bf16_f32 v207, v192, v196
  ds_write_b128 v249, v[204:207] offset:0
  v_cvt_pk_bf16_f32 v208, v169, v173
  v_cvt_pk_bf16_f32 v209, v177, v181
  v_cvt_pk_bf16_f32 v210, v185, v189
  v_cvt_pk_bf16_f32 v211, v193, v197
  ds_write_b128 v249, v[208:211] offset:512
  v_cvt_pk_bf16_f32 v212, v170, v174
  v_cvt_pk_bf16_f32 v213, v178, v182
  v_cvt_pk_bf16_f32 v214, v186, v190
  v_cvt_pk_bf16_f32 v215, v194, v198
  ds_write_b128 v249, v[212:215] offset:1024
  v_cvt_pk_bf16_f32 v216, v171, v175
  v_cvt_pk_bf16_f32 v217, v179, v183
  v_cvt_pk_bf16_f32 v218, v187, v191
  v_cvt_pk_bf16_f32 v219, v195, v199
  ds_write_b128 v249, v[216:219] offset:1536
  v_mov_b32 v249, s65
  s_mov_b32 s65, 0
  s_waitcnt lgkmcnt(0)
  s_mov_b64 exec, 1
  ds_add_u32 v249, v250
  s_mov_b64 exec, -1
  s_mov_b32 s45, s42
  s_cmp_ge_u32 s54, 6
  s_cbranch_scc1 KB_GEND
  s_branch KB_NOFIN1
KB_CNO2:
  v_readlane_b32 s61, v252, s54
  v_readlane_b32 s42, v253, s54
  s_add_u32 s54, s54, 1
  s_min_u32 s54, s54, 63
  s_and_b32 s43, s61, 0x3ffff
  s_lshr_b32 s55, s61, 18
  s_mov_b32 s40, 1
  s_branch KB_CN2
KB_CF2:
  v_perm_b32 v204, v108, v104, s30
  v_perm_b32 v205, v116, v112, s30
  v_perm_b32 v206, v124, v120, s30
  v_perm_b32 v207, v132, v128, s30
  v_mfma_f32_16x16x32_bf16 v[200:203], v[220:223], v[240:243], 0
  v_perm_b32 v208, v108, v104, s31
  v_perm_b32 v209, v116, v112, s31
  v_perm_b32 v210, v124, v120, s31
  v_perm_b32 v211, v132, v128, s31
  v_mfma_f32_16x16x32_bf16 v[168:171], v[220:223], v[204:207], 0
  v_perm_b32 v212, v109, v105, s30
  v_perm_b32 v213, v117, v113, s30
  v_perm_b32 v214, v125, v121, s30
  v_perm_b32 v215, v133, v129, s30
  v_mfma_f32_16x16x32_bf16 v[172:175], v[220:223], v[208:211], 0
  v_perm_b32 v216, v109, v105, s31
  v_perm_b32 v217, v117, v113, s31
  v_perm_b32 v218, v125, v121, s31
  v_perm_b32 v219, v133, v129, s31
  v_mfma_f32_16x16x32_bf16 v[176:179], v[220:223], v[212:215], 0
  v_perm_b32 v204, v110, v106, s30
  v_perm_b32 v205, v118, v114, s30
  v_perm_b32 v206, v126, v122, s30
  v_perm_b32 v207, v134, v130, s30
  v_mfma_f32_16x16x32_bf16 v[180:183], v[220:223], v[216:219], 0
  v_perm_b32 v208, v110, v106, s31
  v_perm_b32 v209, v118, v114, s31
  v_perm_b32 v210, v126, v122, s31
  v_perm_b32 v211, v134, v130, s31
  v_mfma_f32_16x16x32_bf16 v[184:187], v[220:223], v[204:207], 0
  v_perm_b32 v212, v111, v107, s30
  v_perm_b32 v213, v119, v115, s30
  v_perm_b32 v214, v127, v123, s30
  v_perm_b32 v215, v135, v131, s30
  v_mfma_f32_16x16x32_bf16 v[188:191], v[220:223], v[208:211], 0
  v_perm_b32 v216, v111, v107, s31
  v_perm_b32 v217, v119, v115, s31
  v_perm_b32 v218, v127, v123, s31
  v_perm_b32 v219, v135, v131, s31
  v_mfma_f32_16x16x32_bf16 v[192:195], v[220:223], v[212:215], 0
  v_mad_u32_u16 v232, v224, s32, v244
  v_mad_u32_u16 v233, v225, s32, v244
  v_mfma_f32_16x16x32_bf16 v[196:199], v[220:223], v[216:219], 0
  s_branch KB_CC2
IAO_7:
  v_readlane_b32 s61, v251, s52
  s_add_u32 s52, s52, 1
  s_min_u32 s52, s52, 63
  s_and_b32 s44, s61, 0x3ffff
  s_bfe_u32 s53, s61, 0x40012
  s_lshr_b32 s64, s61, 14
  s_and_b32 s64, s64, 0x100
  s_branch IA_7
KB_FIN2:
  s_and_b32 s60, s45, 0xfffff
  v_add_u32 v249, s60, v247
  s_mov_b32 s61, 0x3089705f
  v_add_f32 v200, s61, v200
  v_add_f32 v201, s61, v201
  v_add_f32 v202, s61, v202
  v_add_f32 v203, s61, v203
  v_rcp_f32 v200, v200
  v_rcp_f32 v201, v201
  v_rcp_f32 v202, v202
  v_rcp_f32 v203, v203
  s_lshr_b32 s65, s45, 20
  s_lshl_b32 s65, s65, 2
  s_add_u32 s65, s65, 132916
  v_mul_f32 v200, 0.25, v200
  v_mul_f32 v201, 0.25, v201
  v_mul_f32 v202, 0.25, v202
  v_mul_f32 v203, 0.25, v203
  v_pk_mul_f32 v[168:169], v[168:169], v[200:201]
  v_pk_mul_f32 v[170:171], v[170:171], v[202:203]
  v_pk_mul_f32 v[172:173], v[172:173], v[200:201]
  v_pk_mul_f32 v[174:175], v[174:175], v[202:203]
  v_pk_mul_f32 v[176:177], v[176:177], v[200:201]
  v_pk_mul_f32 v[178:179], v[178:179], v[202:203]
  v_pk_mul_f32 v[180:181], v[180:181], v[200:201]
  v_pk_mul_f32 v[182:183], v[182:183], v[202:203]
  v_pk_mul_f32 v[184:185], v[184:185], v[200:201]
  v_pk_mul_f32 v[186:187], v[186:187], v[202:203]
  v_pk_mul_f32 v[188:189], v[188:189], v[200:201]
  v_pk_mul_f32 v[190:191], v[190:191], v[202:203]
  v_pk_mul_f32 v[192:193], v[192:193], v[200:201]
  v_pk_mul_f32 v[194:195], v[194:195], v[202:203]
  v_pk_mul_f32 v[196:197], v[196:197], v[200:201]
  v_pk_mul_f32 v[198:199], v[198:199], v[202:203]
  v_cvt_pk_bf16_f32 v204, v168, v172
  v_cvt_pk_bf16_f32 v205, v176, v180
  v_cvt_pk_bf16_f32 v206, v184, v188
  v_cvt_pk_bf16_f32 v207, v192, v196
  ds_write_b128 v249, v[204:207] offset:0
  v_cvt_pk_bf16_f32 v208, v169, v173
  v_cvt_pk_bf16_f32 v209, v177, v181
  v_cvt_pk_bf16_f32 v210, v185, v189
  v_cvt_pk_bf16_f32 v211, v193, v197
  ds_write_b128 v249, v[208:211] offset:512
  v_cvt_pk_bf16_f32 v212, v170, v174
  v_cvt_pk_bf16_f32 v213, v178, v182
  v_cvt_pk_bf16_f32 v214, v186, v190
  v_cvt_pk_bf16_f32 v215, v194, v198
  ds_write_b128 v249, v[212:215] offset:1024
  v_cvt_pk_bf16_f32 v216, v171, v175
  v_cvt_pk_bf16_f32 v217, v179, v183
  v_cvt_pk_bf16_f32 v218, v187, v191
  v_cvt_pk_bf16_f32 v219, v195, v199
  ds_write_b128 v249, v[216:219] offset:1536
  v_mov_b32 v249, s65
  s_mov_b32 s65, 0
  s_waitcnt lgkmcnt(0)
  s_mov_b64 exec, 1
  ds_add_u32 v249, v250
  s_mov_b64 exec, -1
  s_mov_b32 s45, s42
  s_cmp_ge_u32 s54, 6
  s_cbranch_scc1 KB_GEND
  s_branch KB_NOFIN2
KB_CNO3:
  v_readlane_b32 s61, v252, s54
  v_readlane_b32 s42, v253, s54
  s_add_u32 s54, s54, 1
  s_min_u32 s54, s54, 63
  s_and_b32 s43, s61, 0x3ffff
  s_lshr_b32 s55, s61, 18
  s_mov_b32 s40, 1
  s_branch KB_CN3
KB_CF3:
  v_perm_b32 v204, v140, v136, s30
  v_perm_b32 v205, v148, v144, s30
  v_perm_b32 v206, v156, v152, s30
  v_perm_b32 v207, v164, v160, s30
  v_mfma_f32_16x16x32_bf16 v[200:203], v[36:39], v[240:243], 0
  v_perm_b32 v208, v140, v136, s31
  v_perm_b32 v209, v148, v144, s31
  v_perm_b32 v210, v156, v152, s31
  v_perm_b32 v211, v164, v160, s31
  v_mfma_f32_16x16x32_bf16 v[168:171], v[36:39], v[204:207], 0
  v_perm_b32 v212, v141, v137, s30
  v_perm_b32 v213, v149, v145, s30
  v_perm_b32 v214, v157, v153, s30
  v_perm_b32 v215, v165, v161, s30
  v_mfma_f32_16x16x32_bf16 v[172:175], v[36:39], v[208:211], 0
  v_perm_b32 v216, v141, v137, s31
  v_perm_b32 v217, v149, v145, s31
  v_perm_b32 v218, v157, v153, s31
  v_perm_b32 v219, v165, v161, s31
  v_mfma_f32_16x16x32_bf16 v[176:179], v[36:39], v[212:215], 0
  v_perm_b32 v204, v142, v138, s30
  v_perm_b32 v205, v150, v146, s30
  v_perm_b32 v206, v158, v154, s30
  v_perm_b32 v207, v166, v162, s30
  v_mfma_f32_16x16x32_bf16 v[180:183], v[36:39], v[216:219], 0
  v_perm_b32 v208, v142, v138, s31
  v_perm_b32 v209, v150, v146, s31
  v_perm_b32 v210, v158, v154, s31
  v_perm_b32 v211, v166, v162, s31
  v_mfma_f32_16x16x32_bf16 v[184:187], v[36:39], v[204:207], 0
  v_perm_b32 v212, v143, v139, s30
  v_perm_b32 v213, v151, v147, s30
  v_perm_b32 v214, v159, v155, s30
  v_perm_b32 v215, v167, v163, s30
  v_mfma_f32_16x16x32_bf16 v[188:191], v[36:39], v[208:211], 0
  v_perm_b32 v216, v143, v139, s31
  v_perm_b32 v217, v151, v147, s31
  v_perm_b32 v218, v159, v155, s31
  v_perm_b32 v219, v167, v163, s31
  v_mfma_f32_16x16x32_bf16 v[192:195], v[36:39], v[212:215], 0
  v_mad_u32_u16 v232, v224, s32, v244
  v_mad_u32_u16 v233, v225, s32, v244
  v_mfma_f32_16x16x32_bf16 v[196:199], v[36:39], v[216:219], 0
  s_branch KB_CC3
IAO_8:
  v_readlane_b32 s61, v251, s52
  s_add_u32 s52, s52, 1
  s_min_u32 s52, s52, 63
  s_and_b32 s44, s61, 0x3ffff
  s_bfe_u32 s53, s61, 0x40012
  s_lshr_b32 s64, s61, 14
  s_and_b32 s64, s64, 0x100
  s_branch IA_8
KB_FIN3:
  s_and_b32 s60, s45, 0xfffff
  v_add_u32 v249, s60, v247
  s_mov_b32 s61, 0x3089705f
  v_add_f32 v200, s61, v200
  v_add_f32 v201, s61, v201
  v_add_f32 v202, s61, v202
  v_add_f32 v203, s61, v203
  v_rcp_f32 v200, v200
  v_rcp_f32 v201, v201
  v_rcp_f32 v202, v202
  v_rcp_f32 v203, v203
  s_lshr_b32 s65, s45, 20
  s_lshl_b32 s65, s65, 2
  s_add_u32 s65, s65, 132916
  v_mul_f32 v200, 0.25, v200
  v_mul_f32 v201, 0.25, v201
  v_mul_f32 v202, 0.25, v202
  v_mul_f32 v203, 0.25, v203
  v_pk_mul_f32 v[168:169], v[168:169], v[200:201]
  v_pk_mul_f32 v[170:171], v[170:171], v[202:203]
  v_pk_mul_f32 v[172:173], v[172:173], v[200:201]
  v_pk_mul_f32 v[174:175], v[174:175], v[202:203]
  v_pk_mul_f32 v[176:177], v[176:177], v[200:201]
  v_pk_mul_f32 v[178:179], v[178:179], v[202:203]
  v_pk_mul_f32 v[180:181], v[180:181], v[200:201]
  v_pk_mul_f32 v[182:183], v[182:183], v[202:203]
  v_pk_mul_f32 v[184:185], v[184:185], v[200:201]
  v_pk_mul_f32 v[186:187], v[186:187], v[202:203]
  v_pk_mul_f32 v[188:189], v[188:189], v[200:201]
  v_pk_mul_f32 v[190:191], v[190:191], v[202:203]
  v_pk_mul_f32 v[192:193], v[192:193], v[200:201]
  v_pk_mul_f32 v[194:195], v[194:195], v[202:203]
  v_pk_mul_f32 v[196:197], v[196:197], v[200:201]
  v_pk_mul_f32 v[198:199], v[198:199], v[202:203]
  v_cvt_pk_bf16_f32 v204, v168, v172
  v_cvt_pk_bf16_f32 v205, v176, v180
  v_cvt_pk_bf16_f32 v206, v184, v188
  v_cvt_pk_bf16_f32 v207, v192, v196
  ds_write_b128 v249, v[204:207] offset:0
  v_cvt_pk_bf16_f32 v208, v169, v173
  v_cvt_pk_bf16_f32 v209, v177, v181
  v_cvt_pk_bf16_f32 v210, v185, v189
  v_cvt_pk_bf16_f32 v211, v193, v197
  ds_write_b128 v249, v[208:211] offset:512
  v_cvt_pk_bf16_f32 v212, v170, v174
  v_cvt_pk_bf16_f32 v213, v178, v182
  v_cvt_pk_bf16_f32 v214, v186, v190
  v_cvt_pk_bf16_f32 v215, v194, v198
  ds_write_b128 v249, v[212:215] offset:1024
  v_cvt_pk_bf16_f32 v216, v171, v175
  v_cvt_pk_bf16_f32 v217, v179, v183
  v_cvt_pk_bf16_f32 v218, v187, v191
  v_cvt_pk_bf16_f32 v219, v195, v199
  ds_write_b128 v249, v[216:219] offset:1536
  v_mov_b32 v249, s65
  s_mov_b32 s65, 0
  s_waitcnt lgkmcnt(0)
  s_mov_b64 exec, 1
  ds_add_u32 v249, v250
  s_mov_b64 exec, -1
  s_mov_b32 s45, s42
  s_cmp_ge_u32 s54, 6
  s_cbranch_scc1 KB_GEND
  s_branch KB_NOFIN3
KB_MS:
  s_setprio 3
  v_subrev_u32 v38, 256, v0
  v_lshlrev_b32 v5, 2, v38
  v_add_u32 v5, 126080, v5
  ds_read_b32 v8, v5 offset:0
  ds_read_b32 v9, v5 offset:1024
  ds_read_b32 v10, v5 offset:2048
  ds_read_b32 v11, v5 offset:3072
  ds_read_b32 v12, v5 offset:4096
  s_waitcnt lgkmcnt(0)
  v_readfirstlane_b32 s51, v28
  s_cmp_lg_u32 s51, 0
  s_cbranch_scc1 KB_FALLBACK
  v_cmp_ne_u32 s[36:37], -1, v8
  v_and_b32 v7, 0xffff, v8
  v_lshlrev_b32 v13, 4, v7
  v_cmp_ne_u32 s[38:39], -1, v9
  v_and_b32 v7, 0xffff, v9
  v_lshlrev_b32 v14, 4, v7
  v_cmp_ne_u32 s[40:41], -1, v10
  v_and_b32 v7, 0xffff, v10
  v_lshlrev_b32 v15, 4, v7
  v_cmp_ne_u32 s[42:43], -1, v11
  v_and_b32 v7, 0xffff, v11
  v_lshlrev_b32 v36, 4, v7
  v_cmp_ne_u32 s[44:45], -1, v12
  v_and_b32 v7, 0xffff, v12
  v_lshlrev_b32 v37, 4, v7
  s_mov_b64 exec, s[36:37]
  global_load_dwordx4 v[16:19], v13, s[26:27] sc1
  s_mov_b64 exec, s[38:39]
  global_load_dwordx4 v[20:23], v14, s[26:27] sc1
  s_mov_b64 exec, s[40:41]
  global_load_dwordx4 v[24:27], v15, s[26:27] sc1
  s_mov_b64 exec, s[42:43]
  global_load_dwordx4 v[28:31], v36, s[26:27] sc1
  s_mov_b64 exec, s[44:45]
  global_load_dwordx4 v[32:35], v37, s[26:27] sc1
  s_mov_b64 exec, -1
  v_lshrrev_b32 v7, 16, v8
  v_lshlrev_b32 v7, 5, v7
  v_add_u32 v7, 131344, v7
  s_mov_b64 exec, s[36:37]
  ds_read_b128 v[200:203], v7
  s_mov_b64 exec, -1
  v_lshrrev_b32 v7, 16, v9
  v_lshlrev_b32 v7, 5, v7
  v_add_u32 v7, 131344, v7
  s_mov_b64 exec, s[38:39]
  ds_read_b128 v[204:207], v7
  s_mov_b64 exec, -1
  v_lshrrev_b32 v7, 16, v10
  v_lshlrev_b32 v7, 5, v7
  v_add_u32 v7, 131344, v7
  s_mov_b64 exec, s[40:41]
  ds_read_b128 v[208:211], v7
  s_mov_b64 exec, -1
  v_lshrrev_b32 v7, 16, v11
  v_lshlrev_b32 v7, 5, v7
  v_add_u32 v7, 131344, v7
  s_mov_b64 exec, s[42:43]
  ds_read_b128 v[212:215], v7
  s_mov_b64 exec, -1
  v_lshrrev_b32 v7, 16, v12
  v_lshlrev_b32 v7, 5, v7
  v_add_u32 v7, 131344, v7
  s_mov_b64 exec, s[44:45]
  ds_read_b128 v[216:219], v7
  s_mov_b64 exec, -1
  v_lshlrev_b32 v5, 4, v1
  v_add_u32 v6, 0x10000, v5
  s_mov_b32 s49, 0
  s_waitcnt vmcnt(0)
  s_branch KB_SCHK
KB_SRETRY:
  s_mov_b64 exec, s[36:37]
  global_load_dwordx4 v[16:19], v13, s[26:27] sc1
  s_mov_b64 exec, s[38:39]
  global_load_dwordx4 v[20:23], v14, s[26:27] sc1
  s_mov_b64 exec, s[40:41]
  global_load_dwordx4 v[24:27], v15, s[26:27] sc1
  s_mov_b64 exec, s[42:43]
  global_load_dwordx4 v[28:31], v36, s[26:27] sc1
  s_mov_b64 exec, s[44:45]
  global_load_dwordx4 v[32:35], v37, s[26:27] sc1
  s_mov_b64 exec, -1
  s_waitcnt vmcnt(0)
KB_SCHK:
  s_mov_b64 s[46:47], 0
  s_mov_b64 exec, s[36:37]
  v_cmp_eq_u32 vcc, -1, v16
  s_or_b64 s[46:47], s[46:47], vcc
  v_cmp_eq_u32 vcc, -1, v17
  s_or_b64 s[46:47], s[46:47], vcc
  v_cmp_eq_u32 vcc, -1, v18
  s_or_b64 s[46:47], s[46:47], vcc
  v_cmp_eq_u32 vcc, -1, v19
  s_or_b64 s[46:47], s[46:47], vcc
  s_mov_b64 exec, s[38:39]
  v_cmp_eq_u32 vcc, -1, v20
  s_or_b64 s[46:47], s[46:47], vcc
  v_cmp_eq_u32 vcc, -1, v21
  s_or_b64 s[46:47], s[46:47], vcc
  v_cmp_eq_u32 vcc, -1, v22
  s_or_b64 s[46:47], s[46:47], vcc
  v_cmp_eq_u32 vcc, -1, v23
  s_or_b64 s[46:47], s[46:47], vcc
  s_mov_b64 exec, s[40:41]
  v_cmp_eq_u32 vcc, -1, v24
  s_or_b64 s[46:47], s[46:47], vcc
  v_cmp_eq_u32 vcc, -1, v25
  s_or_b64 s[46:47], s[46:47], vcc
  v_cmp_eq_u32 vcc, -1, v26
  s_or_b64 s[46:47], s[46:47], vcc
  v_cmp_eq_u32 vcc, -1, v27
  s_or_b64 s[46:47], s[46:47], vcc
  s_mov_b64 exec, s[42:43]
  v_cmp_eq_u32 vcc, -1, v28
  s_or_b64 s[46:47], s[46:47], vcc
  v_cmp_eq_u32 vcc, -1, v29
  s_or_b64 s[46:47], s[46:47], vcc
  v_cmp_eq_u32 vcc, -1, v30
  s_or_b64 s[46:47], s[46:47], vcc
  v_cmp_eq_u32 vcc, -1, v31
  s_or_b64 s[46:47], s[46:47], vcc
  s_mov_b64 exec, s[44:45]
  v_cmp_eq_u32 vcc, -1, v32
  s_or_b64 s[46:47], s[46:47], vcc
  v_cmp_eq_u32 vcc, -1, v33
  s_or_b64 s[46:47], s[46:47], vcc
  v_cmp_eq_u32 vcc, -1, v34
  s_or_b64 s[46:47], s[46:47], vcc
  v_cmp_eq_u32 vcc, -1, v35
  s_or_b64 s[46:47], s[46:47], vcc
  s_mov_b64 exec, -1
  s_cmp_eq_u64 s[46:47], 0
  s_cbranch_scc1 KB_SOK
  s_add_u32 s49, s49, 1
  s_cmp_ge_u32 s49, 0x40000
  s_cbranch_scc1 KB_SOK
  s_sleep 2
  s_branch KB_SRETRY
KB_SOK:
  v_mov_b32 v6, 132904
  v_mov_b32 v7, 1
  s_waitcnt lgkmcnt(0)
  s_mov_b64 exec, 1
  ds_add_u32 v6, v7
  s_mov_b64 exec, -1
  s_mov_b32 s60, 0x3e4ccccd
  s_mov_b64 exec, s[36:37]
  v_add_f32 v16, v16, v200
  v_add_f32 v17, v17, v201
  v_add_f32 v18, v18, v202
  v_add_f32 v19, v19, v203
  v_mul_f32 v200, s60, v16
  v_mul_f32 v201, s60, v17
  v_mul_f32 v202, s60, v18
  v_mul_f32 v203, s60, v19
  v_max_f32 v16, v16, v200
  v_max_f32 v17, v17, v201
  v_max_f32 v18, v18, v202
  v_max_f32 v19, v19, v203
  v_exp_f32 v16, v16
  v_exp_f32 v17, v17
  v_exp_f32 v18, v18
  v_exp_f32 v19, v19
  v_add_u32 v6, 0, v38
  v_lshrrev_b32 v7, 7, v6
  v_mul_u32_u24 v7, 4352, v7
  v_and_b32 v6, 127, v6
  v_lshl_add_u32 v7, v6, 1, v7
  v_bfe_u32 v6, v8, 16, 2
  v_mul_u32_u24 v6, 1088, v6
  v_add_u32 v7, v7, v6
  v_add_u32 v7, 82560, v7
  v_cvt_pk_bf16_f32 v200, v16, v17
  v_cvt_pk_bf16_f32 v201, v18, v19
  ds_write_b16 v7, v200
  ds_write_b16_d16_hi v7, v200 offset:272
  ds_write_b16 v7, v201 offset:544
  ds_write_b16_d16_hi v7, v201 offset:816
  s_mov_b64 exec, s[38:39]
  v_add_f32 v20, v20, v204
  v_add_f32 v21, v21, v205
  v_add_f32 v22, v22, v206
  v_add_f32 v23, v23, v207
  v_mul_f32 v204, s60, v20
  v_mul_f32 v205, s60, v21
  v_mul_f32 v206, s60, v22
  v_mul_f32 v207, s60, v23
  v_max_f32 v20, v20, v204
  v_max_f32 v21, v21, v205
  v_max_f32 v22, v22, v206
  v_max_f32 v23, v23, v207
  v_exp_f32 v20, v20
  v_exp_f32 v21, v21
  v_exp_f32 v22, v22
  v_exp_f32 v23, v23
  v_add_u32 v6, 256, v38
  v_lshrrev_b32 v7, 7, v6
  v_mul_u32_u24 v7, 4352, v7
  v_and_b32 v6, 127, v6
  v_lshl_add_u32 v7, v6, 1, v7
  v_bfe_u32 v6, v9, 16, 2
  v_mul_u32_u24 v6, 1088, v6
  v_add_u32 v7, v7, v6
  v_add_u32 v7, 82560, v7
  v_cvt_pk_bf16_f32 v204, v20, v21
  v_cvt_pk_bf16_f32 v205, v22, v23
  ds_write_b16 v7, v204
  ds_write_b16_d16_hi v7, v204 offset:272
  ds_write_b16 v7, v205 offset:544
  ds_write_b16_d16_hi v7, v205 offset:816
  s_mov_b64 exec, s[40:41]
  v_add_f32 v24, v24, v208
  v_add_f32 v25, v25, v209
  v_add_f32 v26, v26, v210
  v_add_f32 v27, v27, v211
  v_mul_f32 v208, s60, v24
  v_mul_f32 v209, s60, v25
  v_mul_f32 v210, s60, v26
  v_mul_f32 v211, s60, v27
  v_max_f32 v24, v24, v208
  v_max_f32 v25, v25, v209
  v_max_f32 v26, v26, v210
  v_max_f32 v27, v27, v211
  v_exp_f32 v24, v24
  v_exp_f32 v25, v25
  v_exp_f32 v26, v26
  v_exp_f32 v27, v27
  v_add_u32 v6, 512, v38
  v_lshrrev_b32 v7, 7, v6
  v_mul_u32_u24 v7, 4352, v7
  v_and_b32 v6, 127, v6
  v_lshl_add_u32 v7, v6, 1, v7
  v_bfe_u32 v6, v10, 16, 2
  v_mul_u32_u24 v6, 1088, v6
  v_add_u32 v7, v7, v6
  v_add_u32 v7, 82560, v7
  v_cvt_pk_bf16_f32 v208, v24, v25
  v_cvt_pk_bf16_f32 v209, v26, v27
  ds_write_b16 v7, v208
  ds_write_b16_d16_hi v7, v208 offset:272
  ds_write_b16 v7, v209 offset:544
  ds_write_b16_d16_hi v7, v209 offset:816
  s_mov_b64 exec, s[42:43]
  v_add_f32 v28, v28, v212
  v_add_f32 v29, v29, v213
  v_add_f32 v30, v30, v214
  v_add_f32 v31, v31, v215
  v_mul_f32 v212, s60, v28
  v_mul_f32 v213, s60, v29
  v_mul_f32 v214, s60, v30
  v_mul_f32 v215, s60, v31
  v_max_f32 v28, v28, v212
  v_max_f32 v29, v29, v213
  v_max_f32 v30, v30, v214
  v_max_f32 v31, v31, v215
  v_exp_f32 v28, v28
  v_exp_f32 v29, v29
  v_exp_f32 v30, v30
  v_exp_f32 v31, v31
  v_add_u32 v6, 768, v38
  v_lshrrev_b32 v7, 7, v6
  v_mul_u32_u24 v7, 4352, v7
  v_and_b32 v6, 127, v6
  v_lshl_add_u32 v7, v6, 1, v7
  v_bfe_u32 v6, v11, 16, 2
  v_mul_u32_u24 v6, 1088, v6
  v_add_u32 v7, v7, v6
  v_add_u32 v7, 82560, v7
  v_cvt_pk_bf16_f32 v212, v28, v29
  v_cvt_pk_bf16_f32 v213, v30, v31
  ds_write_b16 v7, v212
  ds_write_b16_d16_hi v7, v212 offset:272
  ds_write_b16 v7, v213 offset:544
  ds_write_b16_d16_hi v7, v213 offset:816
  s_mov_b64 exec, s[44:45]
  v_add_f32 v32, v32, v216
  v_add_f32 v33, v33, v217
  v_add_f32 v34, v34, v218
  v_add_f32 v35, v35, v219
  v_mul_f32 v216, s60, v32
  v_mul_f32 v217, s60, v33
  v_mul_f32 v218, s60, v34
  v_mul_f32 v219, s60, v35
  v_max_f32 v32, v32, v216
  v_max_f32 v33, v33, v217
  v_max_f32 v34, v34, v218
  v_max_f32 v35, v35, v219
  v_exp_f32 v32, v32
  v_exp_f32 v33, v33
  v_exp_f32 v34, v34
  v_exp_f32 v35, v35
  v_add_u32 v6, 1024, v38
  v_lshrrev_b32 v7, 7, v6
  v_mul_u32_u24 v7, 4352, v7
  v_and_b32 v6, 127, v6
  v_lshl_add_u32 v7, v6, 1, v7
  v_bfe_u32 v6, v12, 16, 2
  v_mul_u32_u24 v6, 1088, v6
  v_add_u32 v7, v7, v6
  v_add_u32 v7, 82560, v7
  v_cvt_pk_bf16_f32 v216, v32, v33
  v_cvt_pk_bf16_f32 v217, v34, v35
  ds_write_b16 v7, v216
  ds_write_b16_d16_hi v7, v216 offset:272
  ds_write_b16 v7, v217 offset:544
  ds_write_b16_d16_hi v7, v217 offset:816
  s_mov_b64 exec, -1
  v_mov_b32 v6, 132908
  v_mov_b32 v7, 1
  s_waitcnt lgkmcnt(0)
  s_mov_b64 exec, 1
  ds_add_u32 v6, v7
  s_mov_b64 exec, -1
  s_setprio 0
  s_and_b32 s66, s2, 3
  s_add_u32 s60, s66, 0
  s_and_b32 s60, s60, 3
  s_lshl_b32 s36, s60, 14
  s_add_u32 s37, s36, 8192
  s_lshl_b32 s60, s60, 9
  v_mul_u32_u24 v20, 2064, v2
  v_lshl_add_u32 v20, v3, 4, v20
  v_add_u32 v12, s60, v20
  v_add_u32 v16, 66048, v12
  s_add_u32 s60, s66, 1
  s_and_b32 s60, s60, 3
  s_lshl_b32 s38, s60, 14
  s_add_u32 s39, s38, 8192
  s_lshl_b32 s60, s60, 9
  v_add_u32 v13, s60, v20
  v_add_u32 v17, 66048, v13
  s_add_u32 s60, s66, 2
  s_and_b32 s60, s60, 3
  s_lshl_b32 s40, s60, 14
  s_add_u32 s41, s40, 8192
  s_lshl_b32 s60, s60, 9
  v_add_u32 v14, s60, v20
  v_add_u32 v18, 66048, v14
  s_add_u32 s60, s66, 3
  s_and_b32 s60, s60, 3
  s_lshl_b32 s42, s60, 14
  s_add_u32 s43, s42, 8192
  s_lshl_b32 s60, s60, 9
  v_add_u32 v15, s60, v20
  v_add_u32 v19, 66048, v15
  v_lshlrev_b32 v4, 4, v1
  v_add_u32 v5, 2048, v4
  v_add_u32 v6, 4096, v4
  v_add_u32 v7, 6144, v4
  v_add_u32 v8, 0x10000, v4
  v_add_u32 v9, 0x10000, v5
  v_add_u32 v10, 0x10000, v6
  v_add_u32 v11, 0x10000, v7
  buffer_load_dwordx4 v[40:43], v4, s[20:23], s36 offen
  buffer_load_dwordx4 v[44:47], v4, s[20:23], s36 offen offset:1024
  buffer_load_dwordx4 v[48:51], v8, s[20:23], s36 offen
  buffer_load_dwordx4 v[52:55], v8, s[20:23], s36 offen offset:1024
  buffer_load_dwordx4 v[56:59], v5, s[20:23], s36 offen
  buffer_load_dwordx4 v[60:63], v5, s[20:23], s36 offen offset:1024
  buffer_load_dwordx4 v[64:67], v9, s[20:23], s36 offen
  buffer_load_dwordx4 v[68:71], v9, s[20:23], s36 offen offset:1024
  buffer_load_dwordx4 v[72:75], v6, s[20:23], s36 offen
  buffer_load_dwordx4 v[76:79], v6, s[20:23], s36 offen offset:1024
  buffer_load_dwordx4 v[80:83], v10, s[20:23], s36 offen
  buffer_load_dwordx4 v[84:87], v10, s[20:23], s36 offen offset:1024
  buffer_load_dwordx4 v[88:91], v7, s[20:23], s36 offen
  buffer_load_dwordx4 v[92:95], v7, s[20:23], s36 offen offset:1024
  buffer_load_dwordx4 v[96:99], v11, s[20:23], s36 offen
  buffer_load_dwordx4 v[100:103], v11, s[20:23], s36 offen offset:1024
  s_branch KB_MW2
KB_FALLBACK:
  s_mov_b32 s62, 0
  v_lshlrev_b32 v48, 3, v1
  v_lshlrev_b32 v49, 2, v1
  s_mov_b32 s66, 0x3e4ccccd
  s_mov_b32 s67, 0xffff0000
KF_NODE:
  s_mul_i32 s63, s28, 5
  s_add_u32 s63, s63, s62
  s_add_u32 s64, s63, s29
  v_mov_b32 v16, 0
  v_mov_b32 v17, 0
  v_mov_b32 v18, 0
  v_mov_b32 v19, 0
  v_mov_b32 v20, 0
  v_mov_b32 v21, 0
  v_mov_b32 v22, 0
  v_mov_b32 v23, 0
  v_mov_b32 v24, 0
  v_mov_b32 v25, 0
  v_mov_b32 v26, 0
  v_mov_b32 v27, 0
  v_mov_b32 v28, 0
  v_mov_b32 v29, 0
  v_mov_b32 v30, 0
  v_mov_b32 v31, 0
  v_mov_b32 v32, 0
  v_mov_b32 v33, 0
  v_mov_b32 v34, 0
  v_mov_b32 v35, 0
  s_lshl_b32 s60, s63, 5
  s_add_u32 s60, s60, 131344
  v_mov_b32 v7, s60
  ds_read_b128 v[36:39], v7
  s_mov_b32 s65, 0
KF_CHUNK:
  v_add_u32 v50, s65, v49
  global_load_dword v40, v50, s[8:9]
  global_load_dword v41, v50, s[6:7]
  s_waitcnt vmcnt(0) lgkmcnt(0)
  v_cmp_eq_u32 s[68:69], s64, v40
  s_nop 1
KF_EDGE:
  s_cmp_eq_u64 s[68:69], 0
  s_cbranch_scc1 KF_NEXT
  s_ff1_i32_b64 s60, s[68:69]
  s_bitset0_b64 s[68:69], s60
  v_readlane_b32 s61, v41, s60
  s_nop 3
  s_lshl_b32 s60, s61, 9
  v_add_u32 v50, s60, v48
  buffer_load_dwordx2 v[42:43], v50, s[16:19], 0 offen
  s_lshl_b32 s60, s61, 4
  v_mov_b32 v51, s60
  s_mov_b32 s61, 0
KF_SRETRY:
  global_load_dwordx4 v[44:47], v51, s[26:27] sc1
  s_waitcnt vmcnt(0)
  s_mov_b64 s[42:43], 0
  v_cmp_eq_u32 vcc, -1, v44
  s_or_b64 s[42:43], s[42:43], vcc
  v_cmp_eq_u32 vcc, -1, v45
  s_or_b64 s[42:43], s[42:43], vcc
  v_cmp_eq_u32 vcc, -1, v46
  s_or_b64 s[42:43], s[42:43], vcc
  v_cmp_eq_u32 vcc, -1, v47
  s_or_b64 s[42:43], s[42:43], vcc
  s_cmp_eq_u64 s[42:43], 0
  s_cbranch_scc1 KF_SOK
  s_add_u32 s61, s61, 1
  s_cmp_ge_u32 s61, 0x40000
  s_cbranch_scc1 KF_SOK
  s_sleep 4
  s_branch KF_SRETRY
KF_SOK:
  v_add_f32 v44, v44, v36
  v_mul_f32 v52, s66, v44
  v_max_f32 v44, v44, v52
  v_exp_f32 v44, v44
  v_add_f32 v45, v45, v37
  v_mul_f32 v52, s66, v45
  v_max_f32 v45, v45, v52
  v_exp_f32 v45, v45
  v_add_f32 v46, v46, v38
  v_mul_f32 v52, s66, v46
  v_max_f32 v46, v46, v52
  v_exp_f32 v46, v46
  v_add_f32 v47, v47, v39
  v_mul_f32 v52, s66, v47
  v_max_f32 v47, v47, v52
  v_exp_f32 v47, v47
  s_nop 0
  v_cvt_pk_bf16_f32 v52, v44, v45
  v_cvt_pk_bf16_f32 v53, v46, v47
  v_lshlrev_b32 v44, 16, v52
  v_and_b32 v45, s67, v52
  v_lshlrev_b32 v46, 16, v53
  v_and_b32 v47, s67, v53
  v_lshlrev_b32 v52, 16, v42
  v_and_b32 v53, s67, v42
  v_lshlrev_b32 v54, 16, v43
  v_and_b32 v55, s67, v43
  v_add_f32 v32, v32, v44
  v_fma_f32 v16, v44, v52, v16
  v_fma_f32 v17, v44, v53, v17
  v_fma_f32 v18, v44, v54, v18
  v_fma_f32 v19, v44, v55, v19
  v_add_f32 v33, v33, v45
  v_fma_f32 v20, v45, v52, v20
  v_fma_f32 v21, v45, v53, v21
  v_fma_f32 v22, v45, v54, v22
  v_fma_f32 v23, v45, v55, v23
  v_add_f32 v34, v34, v46
  v_fma_f32 v24, v46, v52, v24
  v_fma_f32 v25, v46, v53, v25
  v_fma_f32 v26, v46, v54, v26
  v_fma_f32 v27, v46, v55, v27
  v_add_f32 v35, v35, v47
  v_fma_f32 v28, v47, v52, v28
  v_fma_f32 v29, v47, v53, v29
  v_fma_f32 v30, v47, v54, v30
  v_fma_f32 v31, v47, v55, v31
  s_branch KF_EDGE
KF_NEXT:
  s_add_u32 s65, s65, 256
  s_cmp_lt_u32 s65, 640000
  s_cbranch_scc1 KF_CHUNK
  s_mov_b32 s61, 0x3089705f
  s_mul_i32 s60, s63, 2064
  v_add_u32 v50, s60, v48
  v_add_f32 v32, s61, v32
  v_rcp_f32 v32, v32
  s_nop 0
  v_mul_f32 v32, 0.25, v32
  v_mul_f32 v16, v16, v32
  v_mul_f32 v17, v17, v32
  v_mul_f32 v18, v18, v32
  v_mul_f32 v19, v19, v32
  v_cvt_pk_bf16_f32 v52, v16, v17
  v_cvt_pk_bf16_f32 v53, v18, v19
  ds_write_b64 v50, v[52:53] offset:0
  v_add_f32 v33, s61, v33
  v_rcp_f32 v33, v33
  s_nop 0
  v_mul_f32 v33, 0.25, v33
  v_mul_f32 v20, v20, v33
  v_mul_f32 v21, v21, v33
  v_mul_f32 v22, v22, v33
  v_mul_f32 v23, v23, v33
  v_cvt_pk_bf16_f32 v52, v20, v21
  v_cvt_pk_bf16_f32 v53, v22, v23
  ds_write_b64 v50, v[52:53] offset:512
  v_add_f32 v34, s61, v34
  v_rcp_f32 v34, v34
  s_nop 0
  v_mul_f32 v34, 0.25, v34
  v_mul_f32 v24, v24, v34
  v_mul_f32 v25, v25, v34
  v_mul_f32 v26, v26, v34
  v_mul_f32 v27, v27, v34
  v_cvt_pk_bf16_f32 v52, v24, v25
  v_cvt_pk_bf16_f32 v53, v26, v27
  ds_write_b64 v50, v[52:53] offset:1024
  v_add_f32 v35, s61, v35
  v_rcp_f32 v35, v35
  s_nop 0
  v_mul_f32 v35, 0.25, v35
  v_mul_f32 v28, v28, v35
  v_mul_f32 v29, v29, v35
  v_mul_f32 v30, v30, v35
  v_mul_f32 v31, v31, v35
  v_cvt_pk_bf16_f32 v52, v28, v29
  v_cvt_pk_bf16_f32 v53, v30, v31
  ds_write_b64 v50, v[52:53] offset:1536
  s_add_u32 s62, s62, 1
  s_cmp_lt_u32 s62, 5
  s_cbranch_scc1 KF_NODE
  v_mov_b32 v7, 132916
  v_mov_b32 v8, 10
  v_mov_b32 v9, 10
  ds_write_b64 v7, v[8:9]
  s_waitcnt vmcnt(0) lgkmcnt(0)
  s_barrier
  s_cmp_lt_u32 s28, 4
  s_cbranch_scc1 KB_END
KB_MW:
  s_and_b32 s66, s2, 3
  s_add_u32 s60, s66, 0
  s_and_b32 s60, s60, 3
  s_lshl_b32 s36, s60, 14
  s_add_u32 s37, s36, 8192
  s_lshl_b32 s60, s60, 9
  v_mul_u32_u24 v20, 2064, v2
  v_lshl_add_u32 v20, v3, 4, v20
  v_add_u32 v12, s60, v20
  v_add_u32 v16, 66048, v12
  s_add_u32 s60, s66, 1
  s_and_b32 s60, s60, 3
  s_lshl_b32 s38, s60, 14
  s_add_u32 s39, s38, 8192
  s_lshl_b32 s60, s60, 9
  v_add_u32 v13, s60, v20
  v_add_u32 v17, 66048, v13
  s_add_u32 s60, s66, 2
  s_and_b32 s60, s60, 3
  s_lshl_b32 s40, s60, 14
  s_add_u32 s41, s40, 8192
  s_lshl_b32 s60, s60, 9
  v_add_u32 v14, s60, v20
  v_add_u32 v18, 66048, v14
  s_add_u32 s60, s66, 3
  s_and_b32 s60, s60, 3
  s_lshl_b32 s42, s60, 14
  s_add_u32 s43, s42, 8192
  s_lshl_b32 s60, s60, 9
  v_add_u32 v15, s60, v20
  v_add_u32 v19, 66048, v15
  v_lshlrev_b32 v4, 4, v1
  v_add_u32 v5, 2048, v4
  v_add_u32 v6, 4096, v4
  v_add_u32 v7, 6144, v4
  v_add_u32 v8, 0x10000, v4
  v_add_u32 v9, 0x10000, v5
  v_add_u32 v10, 0x10000, v6
  v_add_u32 v11, 0x10000, v7
  buffer_load_dwordx4 v[40:43], v4, s[20:23], s36 offen
  buffer_load_dwordx4 v[44:47], v4, s[20:23], s36 offen offset:1024
  buffer_load_dwordx4 v[48:51], v8, s[20:23], s36 offen
  buffer_load_dwordx4 v[52:55], v8, s[20:23], s36 offen offset:1024
  buffer_load_dwordx4 v[56:59], v5, s[20:23], s36 offen
  buffer_load_dwordx4 v[60:63], v5, s[20:23], s36 offen offset:1024
  buffer_load_dwordx4 v[64:67], v9, s[20:23], s36 offen
  buffer_load_dwordx4 v[68:71], v9, s[20:23], s36 offen offset:1024
  buffer_load_dwordx4 v[72:75], v6, s[20:23], s36 offen
  buffer_load_dwordx4 v[76:79], v6, s[20:23], s36 offen offset:1024
  buffer_load_dwordx4 v[80:83], v10, s[20:23], s36 offen
  buffer_load_dwordx4 v[84:87], v10, s[20:23], s36 offen offset:1024
  buffer_load_dwordx4 v[88:91], v7, s[20:23], s36 offen
  buffer_load_dwordx4 v[92:95], v7, s[20:23], s36 offen offset:1024
  buffer_load_dwordx4 v[96:99], v11, s[20:23], s36 offen
  buffer_load_dwordx4 v[100:103], v11, s[20:23], s36 offen offset:1024
KB_MW2:
  v_mov_b32 v22, 132916
KB_POLL0:
  ds_read_b32 v23, v22
  s_waitcnt lgkmcnt(0)
  v_readfirstlane_b32 s60, v23
  s_cmp_ge_u32 s60, 10
  s_cbranch_scc1 KB_POLLD0
  s_sleep 2
  s_branch KB_POLL0
KB_POLLD0:
  ds_read_b128 v[200:203], v12 offset:0
  ds_read_b128 v[204:207], v12 offset:33024
  ds_read_b128 v[208:211], v16 offset:0
  ds_read_b128 v[212:215], v12 offset:64
  ds_read_b128 v[216:219], v12 offset:33088
  ds_read_b128 v[220:223], v16 offset:64
  s_waitcnt vmcnt(12)
  s_waitcnt lgkmcnt(3)
  v_mfma_f32_16x16x32_bf16 v[224:227], v[40:43], v[200:203], 0
  v_mfma_f32_16x16x32_bf16 v[228:231], v[44:47], v[200:203], 0
  v_mfma_f32_16x16x32_bf16 v[232:235], v[48:51], v[200:203], 0
  v_mfma_f32_16x16x32_bf16 v[236:239], v[52:55], v[200:203], 0
  v_mfma_f32_16x16x32_bf16 v[240:243], v[40:43], v[204:207], 0
  v_mfma_f32_16x16x32_bf16 v[244:247], v[44:47], v[204:207], 0
  v_mfma_f32_16x16x32_bf16 v[248:251], v[48:51], v[204:207], 0
  v_mfma_f32_16x16x32_bf16 v[252:255], v[52:55], v[204:207], 0
  v_mfma_f32_16x16x32_bf16 v[24:27], v[40:43], v[208:211], 0
  v_mfma_f32_16x16x32_bf16 v[28:31], v[44:47], v[208:211], 0
  v_mfma_f32_16x16x32_bf16 v[32:35], v[48:51], v[208:211], 0
  v_mfma_f32_16x16x32_bf16 v[36:39], v[52:55], v[208:211], 0
  buffer_load_dwordx4 v[40:43], v4, s[20:23], s38 offen
  buffer_load_dwordx4 v[44:47], v4, s[20:23], s38 offen offset:1024
  buffer_load_dwordx4 v[48:51], v8, s[20:23], s38 offen
  buffer_load_dwordx4 v[52:55], v8, s[20:23], s38 offen offset:1024
  ds_read_b128 v[200:203], v12 offset:128
  ds_read_b128 v[204:207], v12 offset:33152
  ds_read_b128 v[208:211], v16 offset:128
  s_waitcnt vmcnt(12)
  s_waitcnt lgkmcnt(3)
  v_mfma_f32_16x16x32_bf16 v[224:227], v[56:59], v[212:215], v[224:227]
  v_mfma_f32_16x16x32_bf16 v[228:231], v[60:63], v[212:215], v[228:231]
  v_mfma_f32_16x16x32_bf16 v[232:235], v[64:67], v[212:215], v[232:235]
  v_mfma_f32_16x16x32_bf16 v[236:239], v[68:71], v[212:215], v[236:239]
  v_mfma_f32_16x16x32_bf16 v[240:243], v[56:59], v[216:219], v[240:243]
  v_mfma_f32_16x16x32_bf16 v[244:247], v[60:63], v[216:219], v[244:247]
  v_mfma_f32_16x16x32_bf16 v[248:251], v[64:67], v[216:219], v[248:251]
  v_mfma_f32_16x16x32_bf16 v[252:255], v[68:71], v[216:219], v[252:255]
  v_mfma_f32_16x16x32_bf16 v[24:27], v[56:59], v[220:223], v[24:27]
  v_mfma_f32_16x16x32_bf16 v[28:31], v[60:63], v[220:223], v[28:31]
  v_mfma_f32_16x16x32_bf16 v[32:35], v[64:67], v[220:223], v[32:35]
  v_mfma_f32_16x16x32_bf16 v[36:39], v[68:71], v[220:223], v[36:39]
  buffer_load_dwordx4 v[56:59], v5, s[20:23], s38 offen
  buffer_load_dwordx4 v[60:63], v5, s[20:23], s38 offen offset:1024
  buffer_load_dwordx4 v[64:67], v9, s[20:23], s38 offen
  buffer_load_dwordx4 v[68:71], v9, s[20:23], s38 offen offset:1024
  ds_read_b128 v[212:215], v12 offset:192
  ds_read_b128 v[216:219], v12 offset:33216
  ds_read_b128 v[220:223], v16 offset:192
  s_waitcnt vmcnt(12)
  s_waitcnt lgkmcnt(3)
  v_mfma_f32_16x16x32_bf16 v[224:227], v[72:75], v[200:203], v[224:227]
  v_mfma_f32_16x16x32_bf16 v[228:231], v[76:79], v[200:203], v[228:231]
  v_mfma_f32_16x16x32_bf16 v[232:235], v[80:83], v[200:203], v[232:235]
  v_mfma_f32_16x16x32_bf16 v[236:239], v[84:87], v[200:203], v[236:239]
  v_mfma_f32_16x16x32_bf16 v[240:243], v[72:75], v[204:207], v[240:243]
  v_mfma_f32_16x16x32_bf16 v[244:247], v[76:79], v[204:207], v[244:247]
  v_mfma_f32_16x16x32_bf16 v[248:251], v[80:83], v[204:207], v[248:251]
  v_mfma_f32_16x16x32_bf16 v[252:255], v[84:87], v[204:207], v[252:255]
  v_mfma_f32_16x16x32_bf16 v[24:27], v[72:75], v[208:211], v[24:27]
  v_mfma_f32_16x16x32_bf16 v[28:31], v[76:79], v[208:211], v[28:31]
  v_mfma_f32_16x16x32_bf16 v[32:35], v[80:83], v[208:211], v[32:35]
  v_mfma_f32_16x16x32_bf16 v[36:39], v[84:87], v[208:211], v[36:39]
  buffer_load_dwordx4 v[72:75], v6, s[20:23], s38 offen
  buffer_load_dwordx4 v[76:79], v6, s[20:23], s38 offen offset:1024
  buffer_load_dwordx4 v[80:83], v10, s[20:23], s38 offen
  buffer_load_dwordx4 v[84:87], v10, s[20:23], s38 offen offset:1024
  ds_read_b128 v[200:203], v13 offset:0
  ds_read_b128 v[204:207], v13 offset:33024
  ds_read_b128 v[208:211], v17 offset:0
  s_waitcnt vmcnt(12)
  s_waitcnt lgkmcnt(3)
  v_mfma_f32_16x16x32_bf16 v[224:227], v[88:91], v[212:215], v[224:227]
  v_mfma_f32_16x16x32_bf16 v[228:231], v[92:95], v[212:215], v[228:231]
  v_mfma_f32_16x16x32_bf16 v[232:235], v[96:99], v[212:215], v[232:235]
  v_mfma_f32_16x16x32_bf16 v[236:239], v[100:103], v[212:215], v[236:239]
  v_mfma_f32_16x16x32_bf16 v[240:243], v[88:91], v[216:219], v[240:243]
  v_mfma_f32_16x16x32_bf16 v[244:247], v[92:95], v[216:219], v[244:247]
  v_mfma_f32_16x16x32_bf16 v[248:251], v[96:99], v[216:219], v[248:251]
  v_mfma_f32_16x16x32_bf16 v[252:255], v[100:103], v[216:219], v[252:255]
  v_mfma_f32_16x16x32_bf16 v[24:27], v[88:91], v[220:223], v[24:27]
  v_mfma_f32_16x16x32_bf16 v[28:31], v[92:95], v[220:223], v[28:31]
  v_mfma_f32_16x16x32_bf16 v[32:35], v[96:99], v[220:223], v[32:35]
  v_mfma_f32_16x16x32_bf16 v[36:39], v[100:103], v[220:223], v[36:39]
  buffer_load_dwordx4 v[88:91], v7, s[20:23], s38 offen
  buffer_load_dwordx4 v[92:95], v7, s[20:23], s38 offen offset:1024
  buffer_load_dwordx4 v[96:99], v11, s[20:23], s38 offen
  buffer_load_dwordx4 v[100:103], v11, s[20:23], s38 offen offset:1024
  ds_read_b128 v[212:215], v13 offset:64
  ds_read_b128 v[216:219], v13 offset:33088
  ds_read_b128 v[220:223], v17 offset:64
  s_waitcnt vmcnt(12)
  s_waitcnt lgkmcnt(3)
  v_mfma_f32_16x16x32_bf16 v[224:227], v[40:43], v[200:203], v[224:227]
  v_mfma_f32_16x16x32_bf16 v[228:231], v[44:47], v[200:203], v[228:231]
  v_mfma_f32_16x16x32_bf16 v[232:235], v[48:51], v[200:203], v[232:235]
  v_mfma_f32_16x16x32_bf16 v[236:239], v[52:55], v[200:203], v[236:239]
  v_mfma_f32_16x16x32_bf16 v[240:243], v[40:43], v[204:207], v[240:243]
  v_mfma_f32_16x16x32_bf16 v[244:247], v[44:47], v[204:207], v[244:247]
  v_mfma_f32_16x16x32_bf16 v[248:251], v[48:51], v[204:207], v[248:251]
  v_mfma_f32_16x16x32_bf16 v[252:255], v[52:55], v[204:207], v[252:255]
  v_mfma_f32_16x16x32_bf16 v[24:27], v[40:43], v[208:211], v[24:27]
  v_mfma_f32_16x16x32_bf16 v[28:31], v[44:47], v[208:211], v[28:31]
  v_mfma_f32_16x16x32_bf16 v[32:35], v[48:51], v[208:211], v[32:35]
  v_mfma_f32_16x16x32_bf16 v[36:39], v[52:55], v[208:211], v[36:39]
  buffer_load_dwordx4 v[40:43], v4, s[20:23], s40 offen
  buffer_load_dwordx4 v[44:47], v4, s[20:23], s40 offen offset:1024
  buffer_load_dwordx4 v[48:51], v8, s[20:23], s40 offen
  buffer_load_dwordx4 v[52:55], v8, s[20:23], s40 offen offset:1024
  ds_read_b128 v[200:203], v13 offset:128
  ds_read_b128 v[204:207], v13 offset:33152
  ds_read_b128 v[208:211], v17 offset:128
  s_waitcnt vmcnt(12)
  s_waitcnt lgkmcnt(3)
  v_mfma_f32_16x16x32_bf16 v[224:227], v[56:59], v[212:215], v[224:227]
  v_mfma_f32_16x16x32_bf16 v[228:231], v[60:63], v[212:215], v[228:231]
  v_mfma_f32_16x16x32_bf16 v[232:235], v[64:67], v[212:215], v[232:235]
  v_mfma_f32_16x16x32_bf16 v[236:239], v[68:71], v[212:215], v[236:239]
  v_mfma_f32_16x16x32_bf16 v[240:243], v[56:59], v[216:219], v[240:243]
  v_mfma_f32_16x16x32_bf16 v[244:247], v[60:63], v[216:219], v[244:247]
  v_mfma_f32_16x16x32_bf16 v[248:251], v[64:67], v[216:219], v[248:251]
  v_mfma_f32_16x16x32_bf16 v[252:255], v[68:71], v[216:219], v[252:255]
  v_mfma_f32_16x16x32_bf16 v[24:27], v[56:59], v[220:223], v[24:27]
  v_mfma_f32_16x16x32_bf16 v[28:31], v[60:63], v[220:223], v[28:31]
  v_mfma_f32_16x16x32_bf16 v[32:35], v[64:67], v[220:223], v[32:35]
  v_mfma_f32_16x16x32_bf16 v[36:39], v[68:71], v[220:223], v[36:39]
  buffer_load_dwordx4 v[56:59], v5, s[20:23], s40 offen
  buffer_load_dwordx4 v[60:63], v5, s[20:23], s40 offen offset:1024
  buffer_load_dwordx4 v[64:67], v9, s[20:23], s40 offen
  buffer_load_dwordx4 v[68:71], v9, s[20:23], s40 offen offset:1024
  ds_read_b128 v[212:215], v13 offset:192
  ds_read_b128 v[216:219], v13 offset:33216
  ds_read_b128 v[220:223], v17 offset:192
  s_waitcnt vmcnt(12)
  s_waitcnt lgkmcnt(3)
  v_mfma_f32_16x16x32_bf16 v[224:227], v[72:75], v[200:203], v[224:227]
  v_mfma_f32_16x16x32_bf16 v[228:231], v[76:79], v[200:203], v[228:231]
  v_mfma_f32_16x16x32_bf16 v[232:235], v[80:83], v[200:203], v[232:235]
  v_mfma_f32_16x16x32_bf16 v[236:239], v[84:87], v[200:203], v[236:239]
  v_mfma_f32_16x16x32_bf16 v[240:243], v[72:75], v[204:207], v[240:243]
  v_mfma_f32_16x16x32_bf16 v[244:247], v[76:79], v[204:207], v[244:247]
  v_mfma_f32_16x16x32_bf16 v[248:251], v[80:83], v[204:207], v[248:251]
  v_mfma_f32_16x16x32_bf16 v[252:255], v[84:87], v[204:207], v[252:255]
  v_mfma_f32_16x16x32_bf16 v[24:27], v[72:75], v[208:211], v[24:27]
  v_mfma_f32_16x16x32_bf16 v[28:31], v[76:79], v[208:211], v[28:31]
  v_mfma_f32_16x16x32_bf16 v[32:35], v[80:83], v[208:211], v[32:35]
  v_mfma_f32_16x16x32_bf16 v[36:39], v[84:87], v[208:211], v[36:39]
  buffer_load_dwordx4 v[72:75], v6, s[20:23], s40 offen
  buffer_load_dwordx4 v[76:79], v6, s[20:23], s40 offen offset:1024
  buffer_load_dwordx4 v[80:83], v10, s[20:23], s40 offen
  buffer_load_dwordx4 v[84:87], v10, s[20:23], s40 offen offset:1024
  ds_read_b128 v[200:203], v14 offset:0
  ds_read_b128 v[204:207], v14 offset:33024
  ds_read_b128 v[208:211], v18 offset:0
  s_waitcnt vmcnt(12)
  s_waitcnt lgkmcnt(3)
  v_mfma_f32_16x16x32_bf16 v[224:227], v[88:91], v[212:215], v[224:227]
  v_mfma_f32_16x16x32_bf16 v[228:231], v[92:95], v[212:215], v[228:231]
  v_mfma_f32_16x16x32_bf16 v[232:235], v[96:99], v[212:215], v[232:235]
  v_mfma_f32_16x16x32_bf16 v[236:239], v[100:103], v[212:215], v[236:239]
  v_mfma_f32_16x16x32_bf16 v[240:243], v[88:91], v[216:219], v[240:243]
  v_mfma_f32_16x16x32_bf16 v[244:247], v[92:95], v[216:219], v[244:247]
  v_mfma_f32_16x16x32_bf16 v[248:251], v[96:99], v[216:219], v[248:251]
  v_mfma_f32_16x16x32_bf16 v[252:255], v[100:103], v[216:219], v[252:255]
  v_mfma_f32_16x16x32_bf16 v[24:27], v[88:91], v[220:223], v[24:27]
  v_mfma_f32_16x16x32_bf16 v[28:31], v[92:95], v[220:223], v[28:31]
  v_mfma_f32_16x16x32_bf16 v[32:35], v[96:99], v[220:223], v[32:35]
  v_mfma_f32_16x16x32_bf16 v[36:39], v[100:103], v[220:223], v[36:39]
  buffer_load_dwordx4 v[88:91], v7, s[20:23], s40 offen
  buffer_load_dwordx4 v[92:95], v7, s[20:23], s40 offen offset:1024
  buffer_load_dwordx4 v[96:99], v11, s[20:23], s40 offen
  buffer_load_dwordx4 v[100:103], v11, s[20:23], s40 offen offset:1024
  ds_read_b128 v[212:215], v14 offset:64
  ds_read_b128 v[216:219], v14 offset:33088
  ds_read_b128 v[220:223], v18 offset:64
  s_waitcnt vmcnt(12)
  s_waitcnt lgkmcnt(3)
  v_mfma_f32_16x16x32_bf16 v[224:227], v[40:43], v[200:203], v[224:227]
  v_mfma_f32_16x16x32_bf16 v[228:231], v[44:47], v[200:203], v[228:231]
  v_mfma_f32_16x16x32_bf16 v[232:235], v[48:51], v[200:203], v[232:235]
  v_mfma_f32_16x16x32_bf16 v[236:239], v[52:55], v[200:203], v[236:239]
  v_mfma_f32_16x16x32_bf16 v[240:243], v[40:43], v[204:207], v[240:243]
  v_mfma_f32_16x16x32_bf16 v[244:247], v[44:47], v[204:207], v[244:247]
  v_mfma_f32_16x16x32_bf16 v[248:251], v[48:51], v[204:207], v[248:251]
  v_mfma_f32_16x16x32_bf16 v[252:255], v[52:55], v[204:207], v[252:255]
  v_mfma_f32_16x16x32_bf16 v[24:27], v[40:43], v[208:211], v[24:27]
  v_mfma_f32_16x16x32_bf16 v[28:31], v[44:47], v[208:211], v[28:31]
  v_mfma_f32_16x16x32_bf16 v[32:35], v[48:51], v[208:211], v[32:35]
  v_mfma_f32_16x16x32_bf16 v[36:39], v[52:55], v[208:211], v[36:39]
  buffer_load_dwordx4 v[40:43], v4, s[20:23], s42 offen
  buffer_load_dwordx4 v[44:47], v4, s[20:23], s42 offen offset:1024
  buffer_load_dwordx4 v[48:51], v8, s[20:23], s42 offen
  buffer_load_dwordx4 v[52:55], v8, s[20:23], s42 offen offset:1024
  ds_read_b128 v[200:203], v14 offset:128
  ds_read_b128 v[204:207], v14 offset:33152
  ds_read_b128 v[208:211], v18 offset:128
  s_waitcnt vmcnt(12)
  s_waitcnt lgkmcnt(3)
  v_mfma_f32_16x16x32_bf16 v[224:227], v[56:59], v[212:215], v[224:227]
  v_mfma_f32_16x16x32_bf16 v[228:231], v[60:63], v[212:215], v[228:231]
  v_mfma_f32_16x16x32_bf16 v[232:235], v[64:67], v[212:215], v[232:235]
  v_mfma_f32_16x16x32_bf16 v[236:239], v[68:71], v[212:215], v[236:239]
  v_mfma_f32_16x16x32_bf16 v[240:243], v[56:59], v[216:219], v[240:243]
  v_mfma_f32_16x16x32_bf16 v[244:247], v[60:63], v[216:219], v[244:247]
  v_mfma_f32_16x16x32_bf16 v[248:251], v[64:67], v[216:219], v[248:251]
  v_mfma_f32_16x16x32_bf16 v[252:255], v[68:71], v[216:219], v[252:255]
  v_mfma_f32_16x16x32_bf16 v[24:27], v[56:59], v[220:223], v[24:27]
  v_mfma_f32_16x16x32_bf16 v[28:31], v[60:63], v[220:223], v[28:31]
  v_mfma_f32_16x16x32_bf16 v[32:35], v[64:67], v[220:223], v[32:35]
  v_mfma_f32_16x16x32_bf16 v[36:39], v[68:71], v[220:223], v[36:39]
  buffer_load_dwordx4 v[56:59], v5, s[20:23], s42 offen
  buffer_load_dwordx4 v[60:63], v5, s[20:23], s42 offen offset:1024
  buffer_load_dwordx4 v[64:67], v9, s[20:23], s42 offen
  buffer_load_dwordx4 v[68:71], v9, s[20:23], s42 offen offset:1024
  ds_read_b128 v[212:215], v14 offset:192
  ds_read_b128 v[216:219], v14 offset:33216
  ds_read_b128 v[220:223], v18 offset:192
  s_waitcnt vmcnt(12)
  s_waitcnt lgkmcnt(3)
  v_mfma_f32_16x16x32_bf16 v[224:227], v[72:75], v[200:203], v[224:227]
  v_mfma_f32_16x16x32_bf16 v[228:231], v[76:79], v[200:203], v[228:231]
  v_mfma_f32_16x16x32_bf16 v[232:235], v[80:83], v[200:203], v[232:235]
  v_mfma_f32_16x16x32_bf16 v[236:239], v[84:87], v[200:203], v[236:239]
  v_mfma_f32_16x16x32_bf16 v[240:243], v[72:75], v[204:207], v[240:243]
  v_mfma_f32_16x16x32_bf16 v[244:247], v[76:79], v[204:207], v[244:247]
  v_mfma_f32_16x16x32_bf16 v[248:251], v[80:83], v[204:207], v[248:251]
  v_mfma_f32_16x16x32_bf16 v[252:255], v[84:87], v[204:207], v[252:255]
  v_mfma_f32_16x16x32_bf16 v[24:27], v[72:75], v[208:211], v[24:27]
  v_mfma_f32_16x16x32_bf16 v[28:31], v[76:79], v[208:211], v[28:31]
  v_mfma_f32_16x16x32_bf16 v[32:35], v[80:83], v[208:211], v[32:35]
  v_mfma_f32_16x16x32_bf16 v[36:39], v[84:87], v[208:211], v[36:39]
  buffer_load_dwordx4 v[72:75], v6, s[20:23], s42 offen
  buffer_load_dwordx4 v[76:79], v6, s[20:23], s42 offen offset:1024
  buffer_load_dwordx4 v[80:83], v10, s[20:23], s42 offen
  buffer_load_dwordx4 v[84:87], v10, s[20:23], s42 offen offset:1024
  ds_read_b128 v[200:203], v15 offset:0
  ds_read_b128 v[204:207], v15 offset:33024
  ds_read_b128 v[208:211], v19 offset:0
  s_waitcnt vmcnt(12)
  s_waitcnt lgkmcnt(3)
  v_mfma_f32_16x16x32_bf16 v[224:227], v[88:91], v[212:215], v[224:227]
  v_mfma_f32_16x16x32_bf16 v[228:231], v[92:95], v[212:215], v[228:231]
  v_mfma_f32_16x16x32_bf16 v[232:235], v[96:99], v[212:215], v[232:235]
  v_mfma_f32_16x16x32_bf16 v[236:239], v[100:103], v[212:215], v[236:239]
  v_mfma_f32_16x16x32_bf16 v[240:243], v[88:91], v[216:219], v[240:243]
  v_mfma_f32_16x16x32_bf16 v[244:247], v[92:95], v[216:219], v[244:247]
  v_mfma_f32_16x16x32_bf16 v[248:251], v[96:99], v[216:219], v[248:251]
  v_mfma_f32_16x16x32_bf16 v[252:255], v[100:103], v[216:219], v[252:255]
  v_mfma_f32_16x16x32_bf16 v[24:27], v[88:91], v[220:223], v[24:27]
  v_mfma_f32_16x16x32_bf16 v[28:31], v[92:95], v[220:223], v[28:31]
  v_mfma_f32_16x16x32_bf16 v[32:35], v[96:99], v[220:223], v[32:35]
  v_mfma_f32_16x16x32_bf16 v[36:39], v[100:103], v[220:223], v[36:39]
  buffer_load_dwordx4 v[88:91], v7, s[20:23], s42 offen
  buffer_load_dwordx4 v[92:95], v7, s[20:23], s42 offen offset:1024
  buffer_load_dwordx4 v[96:99], v11, s[20:23], s42 offen
  buffer_load_dwordx4 v[100:103], v11, s[20:23], s42 offen offset:1024
  ds_read_b128 v[212:215], v15 offset:64
  ds_read_b128 v[216:219], v15 offset:33088
  ds_read_b128 v[220:223], v19 offset:64
  s_waitcnt vmcnt(12)
  s_waitcnt lgkmcnt(3)
  v_mfma_f32_16x16x32_bf16 v[224:227], v[40:43], v[200:203], v[224:227]
  v_mfma_f32_16x16x32_bf16 v[228:231], v[44:47], v[200:203], v[228:231]
  v_mfma_f32_16x16x32_bf16 v[232:235], v[48:51], v[200:203], v[232:235]
  v_mfma_f32_16x16x32_bf16 v[236:239], v[52:55], v[200:203], v[236:239]
  v_mfma_f32_16x16x32_bf16 v[240:243], v[40:43], v[204:207], v[240:243]
  v_mfma_f32_16x16x32_bf16 v[244:247], v[44:47], v[204:207], v[244:247]
  v_mfma_f32_16x16x32_bf16 v[248:251], v[48:51], v[204:207], v[248:251]
  v_mfma_f32_16x16x32_bf16 v[252:255], v[52:55], v[204:207], v[252:255]
  v_mfma_f32_16x16x32_bf16 v[24:27], v[40:43], v[208:211], v[24:27]
  v_mfma_f32_16x16x32_bf16 v[28:31], v[44:47], v[208:211], v[28:31]
  v_mfma_f32_16x16x32_bf16 v[32:35], v[48:51], v[208:211], v[32:35]
  v_mfma_f32_16x16x32_bf16 v[36:39], v[52:55], v[208:211], v[36:39]
  buffer_load_dwordx4 v[40:43], v4, s[20:23], s37 offen
  buffer_load_dwordx4 v[44:47], v4, s[20:23], s37 offen offset:1024
  buffer_load_dwordx4 v[48:51], v8, s[20:23], s37 offen
  buffer_load_dwordx4 v[52:55], v8, s[20:23], s37 offen offset:1024
  ds_read_b128 v[200:203], v15 offset:128
  ds_read_b128 v[204:207], v15 offset:33152
  ds_read_b128 v[208:211], v19 offset:128
  s_waitcnt vmcnt(12)
  s_waitcnt lgkmcnt(3)
  v_mfma_f32_16x16x32_bf16 v[224:227], v[56:59], v[212:215], v[224:227]
  v_mfma_f32_16x16x32_bf16 v[228:231], v[60:63], v[212:215], v[228:231]
  v_mfma_f32_16x16x32_bf16 v[232:235], v[64:67], v[212:215], v[232:235]
  v_mfma_f32_16x16x32_bf16 v[236:239], v[68:71], v[212:215], v[236:239]
  v_mfma_f32_16x16x32_bf16 v[240:243], v[56:59], v[216:219], v[240:243]
  v_mfma_f32_16x16x32_bf16 v[244:247], v[60:63], v[216:219], v[244:247]
  v_mfma_f32_16x16x32_bf16 v[248:251], v[64:67], v[216:219], v[248:251]
  v_mfma_f32_16x16x32_bf16 v[252:255], v[68:71], v[216:219], v[252:255]
  v_mfma_f32_16x16x32_bf16 v[24:27], v[56:59], v[220:223], v[24:27]
  v_mfma_f32_16x16x32_bf16 v[28:31], v[60:63], v[220:223], v[28:31]
  v_mfma_f32_16x16x32_bf16 v[32:35], v[64:67], v[220:223], v[32:35]
  v_mfma_f32_16x16x32_bf16 v[36:39], v[68:71], v[220:223], v[36:39]
  buffer_load_dwordx4 v[56:59], v5, s[20:23], s37 offen
  buffer_load_dwordx4 v[60:63], v5, s[20:23], s37 offen offset:1024
  buffer_load_dwordx4 v[64:67], v9, s[20:23], s37 offen
  buffer_load_dwordx4 v[68:71], v9, s[20:23], s37 offen offset:1024
  ds_read_b128 v[212:215], v15 offset:192
  ds_read_b128 v[216:219], v15 offset:33216
  ds_read_b128 v[220:223], v19 offset:192
  s_waitcnt vmcnt(12)
  s_waitcnt lgkmcnt(3)
  v_mfma_f32_16x16x32_bf16 v[224:227], v[72:75], v[200:203], v[224:227]
  v_mfma_f32_16x16x32_bf16 v[228:231], v[76:79], v[200:203], v[228:231]
  v_mfma_f32_16x16x32_bf16 v[232:235], v[80:83], v[200:203], v[232:235]
  v_mfma_f32_16x16x32_bf16 v[236:239], v[84:87], v[200:203], v[236:239]
  v_mfma_f32_16x16x32_bf16 v[240:243], v[72:75], v[204:207], v[240:243]
  v_mfma_f32_16x16x32_bf16 v[244:247], v[76:79], v[204:207], v[244:247]
  v_mfma_f32_16x16x32_bf16 v[248:251], v[80:83], v[204:207], v[248:251]
  v_mfma_f32_16x16x32_bf16 v[252:255], v[84:87], v[204:207], v[252:255]
  v_mfma_f32_16x16x32_bf16 v[24:27], v[72:75], v[208:211], v[24:27]
  v_mfma_f32_16x16x32_bf16 v[28:31], v[76:79], v[208:211], v[28:31]
  v_mfma_f32_16x16x32_bf16 v[32:35], v[80:83], v[208:211], v[32:35]
  v_mfma_f32_16x16x32_bf16 v[36:39], v[84:87], v[208:211], v[36:39]
  buffer_load_dwordx4 v[72:75], v6, s[20:23], s37 offen
  buffer_load_dwordx4 v[76:79], v6, s[20:23], s37 offen offset:1024
  buffer_load_dwordx4 v[80:83], v10, s[20:23], s37 offen
  buffer_load_dwordx4 v[84:87], v10, s[20:23], s37 offen offset:1024
  s_waitcnt vmcnt(12)
  s_waitcnt lgkmcnt(0)
  v_mfma_f32_16x16x32_bf16 v[224:227], v[88:91], v[212:215], v[224:227]
  v_mfma_f32_16x16x32_bf16 v[228:231], v[92:95], v[212:215], v[228:231]
  v_mfma_f32_16x16x32_bf16 v[232:235], v[96:99], v[212:215], v[232:235]
  v_mfma_f32_16x16x32_bf16 v[236:239], v[100:103], v[212:215], v[236:239]
  v_mfma_f32_16x16x32_bf16 v[240:243], v[88:91], v[216:219], v[240:243]
  v_mfma_f32_16x16x32_bf16 v[244:247], v[92:95], v[216:219], v[244:247]
  v_mfma_f32_16x16x32_bf16 v[248:251], v[96:99], v[216:219], v[248:251]
  v_mfma_f32_16x16x32_bf16 v[252:255], v[100:103], v[216:219], v[252:255]
  v_mfma_f32_16x16x32_bf16 v[24:27], v[88:91], v[220:223], v[24:27]
  v_mfma_f32_16x16x32_bf16 v[28:31], v[92:95], v[220:223], v[28:31]
  v_mfma_f32_16x16x32_bf16 v[32:35], v[96:99], v[220:223], v[32:35]
  v_mfma_f32_16x16x32_bf16 v[36:39], v[100:103], v[220:223], v[36:39]
  buffer_load_dwordx4 v[88:91], v7, s[20:23], s37 offen
  buffer_load_dwordx4 v[92:95], v7, s[20:23], s37 offen offset:1024
  buffer_load_dwordx4 v[96:99], v11, s[20:23], s37 offen
  buffer_load_dwordx4 v[100:103], v11, s[20:23], s37 offen offset:1024
  v_mov_b32 v22, 132920
KB_POLL1:
  ds_read_b32 v23, v22
  s_waitcnt lgkmcnt(0)
  v_readfirstlane_b32 s60, v23
  s_cmp_ge_u32 s60, 10
  s_cbranch_scc1 KB_POLLD1
  s_sleep 2
  s_branch KB_POLL1
KB_POLLD1:
  ds_read_b128 v[200:203], v12 offset:256
  ds_read_b128 v[204:207], v12 offset:33280
  ds_read_b128 v[208:211], v16 offset:256
  ds_read_b128 v[212:215], v12 offset:320
  ds_read_b128 v[216:219], v12 offset:33344
  ds_read_b128 v[220:223], v16 offset:320
  s_waitcnt vmcnt(12)
  s_waitcnt lgkmcnt(3)
  v_mfma_f32_16x16x32_bf16 v[224:227], v[40:43], v[200:203], v[224:227]
  v_mfma_f32_16x16x32_bf16 v[228:231], v[44:47], v[200:203], v[228:231]
  v_mfma_f32_16x16x32_bf16 v[232:235], v[48:51], v[200:203], v[232:235]
  v_mfma_f32_16x16x32_bf16 v[236:239], v[52:55], v[200:203], v[236:239]
  v_mfma_f32_16x16x32_bf16 v[240:243], v[40:43], v[204:207], v[240:243]
  v_mfma_f32_16x16x32_bf16 v[244:247], v[44:47], v[204:207], v[244:247]
  v_mfma_f32_16x16x32_bf16 v[248:251], v[48:51], v[204:207], v[248:251]
  v_mfma_f32_16x16x32_bf16 v[252:255], v[52:55], v[204:207], v[252:255]
  v_mfma_f32_16x16x32_bf16 v[24:27], v[40:43], v[208:211], v[24:27]
  v_mfma_f32_16x16x32_bf16 v[28:31], v[44:47], v[208:211], v[28:31]
  v_mfma_f32_16x16x32_bf16 v[32:35], v[48:51], v[208:211], v[32:35]
  v_mfma_f32_16x16x32_bf16 v[36:39], v[52:55], v[208:211], v[36:39]
  buffer_load_dwordx4 v[40:43], v4, s[20:23], s39 offen
  buffer_load_dwordx4 v[44:47], v4, s[20:23], s39 offen offset:1024
  buffer_load_dwordx4 v[48:51], v8, s[20:23], s39 offen
  buffer_load_dwordx4 v[52:55], v8, s[20:23], s39 offen offset:1024
  ds_read_b128 v[200:203], v12 offset:384
  ds_read_b128 v[204:207], v12 offset:33408
  ds_read_b128 v[208:211], v16 offset:384
  s_waitcnt vmcnt(12)
  s_waitcnt lgkmcnt(3)
  v_mfma_f32_16x16x32_bf16 v[224:227], v[56:59], v[212:215], v[224:227]
  v_mfma_f32_16x16x32_bf16 v[228:231], v[60:63], v[212:215], v[228:231]
  v_mfma_f32_16x16x32_bf16 v[232:235], v[64:67], v[212:215], v[232:235]
  v_mfma_f32_16x16x32_bf16 v[236:239], v[68:71], v[212:215], v[236:239]
  v_mfma_f32_16x16x32_bf16 v[240:243], v[56:59], v[216:219], v[240:243]
  v_mfma_f32_16x16x32_bf16 v[244:247], v[60:63], v[216:219], v[244:247]
  v_mfma_f32_16x16x32_bf16 v[248:251], v[64:67], v[216:219], v[248:251]
  v_mfma_f32_16x16x32_bf16 v[252:255], v[68:71], v[216:219], v[252:255]
  v_mfma_f32_16x16x32_bf16 v[24:27], v[56:59], v[220:223], v[24:27]
  v_mfma_f32_16x16x32_bf16 v[28:31], v[60:63], v[220:223], v[28:31]
  v_mfma_f32_16x16x32_bf16 v[32:35], v[64:67], v[220:223], v[32:35]
  v_mfma_f32_16x16x32_bf16 v[36:39], v[68:71], v[220:223], v[36:39]
  buffer_load_dwordx4 v[56:59], v5, s[20:23], s39 offen
  buffer_load_dwordx4 v[60:63], v5, s[20:23], s39 offen offset:1024
  buffer_load_dwordx4 v[64:67], v9, s[20:23], s39 offen
  buffer_load_dwordx4 v[68:71], v9, s[20:23], s39 offen offset:1024
  ds_read_b128 v[212:215], v12 offset:448
  ds_read_b128 v[216:219], v12 offset:33472
  ds_read_b128 v[220:223], v16 offset:448
  s_waitcnt vmcnt(12)
  s_waitcnt lgkmcnt(3)
  v_mfma_f32_16x16x32_bf16 v[224:227], v[72:75], v[200:203], v[224:227]
  v_mfma_f32_16x16x32_bf16 v[228:231], v[76:79], v[200:203], v[228:231]
  v_mfma_f32_16x16x32_bf16 v[232:235], v[80:83], v[200:203], v[232:235]
  v_mfma_f32_16x16x32_bf16 v[236:239], v[84:87], v[200:203], v[236:239]
  v_mfma_f32_16x16x32_bf16 v[240:243], v[72:75], v[204:207], v[240:243]
  v_mfma_f32_16x16x32_bf16 v[244:247], v[76:79], v[204:207], v[244:247]
  v_mfma_f32_16x16x32_bf16 v[248:251], v[80:83], v[204:207], v[248:251]
  v_mfma_f32_16x16x32_bf16 v[252:255], v[84:87], v[204:207], v[252:255]
  v_mfma_f32_16x16x32_bf16 v[24:27], v[72:75], v[208:211], v[24:27]
  v_mfma_f32_16x16x32_bf16 v[28:31], v[76:79], v[208:211], v[28:31]
  v_mfma_f32_16x16x32_bf16 v[32:35], v[80:83], v[208:211], v[32:35]
  v_mfma_f32_16x16x32_bf16 v[36:39], v[84:87], v[208:211], v[36:39]
  buffer_load_dwordx4 v[72:75], v6, s[20:23], s39 offen
  buffer_load_dwordx4 v[76:79], v6, s[20:23], s39 offen offset:1024
  buffer_load_dwordx4 v[80:83], v10, s[20:23], s39 offen
  buffer_load_dwordx4 v[84:87], v10, s[20:23], s39 offen offset:1024
  ds_read_b128 v[200:203], v13 offset:256
  ds_read_b128 v[204:207], v13 offset:33280
  ds_read_b128 v[208:211], v17 offset:256
  s_waitcnt vmcnt(12)
  s_waitcnt lgkmcnt(3)
  v_mfma_f32_16x16x32_bf16 v[224:227], v[88:91], v[212:215], v[224:227]
  v_mfma_f32_16x16x32_bf16 v[228:231], v[92:95], v[212:215], v[228:231]
  v_mfma_f32_16x16x32_bf16 v[232:235], v[96:99], v[212:215], v[232:235]
  v_mfma_f32_16x16x32_bf16 v[236:239], v[100:103], v[212:215], v[236:239]
  v_mfma_f32_16x16x32_bf16 v[240:243], v[88:91], v[216:219], v[240:243]
  v_mfma_f32_16x16x32_bf16 v[244:247], v[92:95], v[216:219], v[244:247]
  v_mfma_f32_16x16x32_bf16 v[248:251], v[96:99], v[216:219], v[248:251]
  v_mfma_f32_16x16x32_bf16 v[252:255], v[100:103], v[216:219], v[252:255]
  v_mfma_f32_16x16x32_bf16 v[24:27], v[88:91], v[220:223], v[24:27]
  v_mfma_f32_16x16x32_bf16 v[28:31], v[92:95], v[220:223], v[28:31]
  v_mfma_f32_16x16x32_bf16 v[32:35], v[96:99], v[220:223], v[32:35]
  v_mfma_f32_16x16x32_bf16 v[36:39], v[100:103], v[220:223], v[36:39]
  buffer_load_dwordx4 v[88:91], v7, s[20:23], s39 offen
  buffer_load_dwordx4 v[92:95], v7, s[20:23], s39 offen offset:1024
  buffer_load_dwordx4 v[96:99], v11, s[20:23], s39 offen
  buffer_load_dwordx4 v[100:103], v11, s[20:23], s39 offen offset:1024
  ds_read_b128 v[212:215], v13 offset:320
  ds_read_b128 v[216:219], v13 offset:33344
  ds_read_b128 v[220:223], v17 offset:320
  s_waitcnt vmcnt(12)
  s_waitcnt lgkmcnt(3)
  v_mfma_f32_16x16x32_bf16 v[224:227], v[40:43], v[200:203], v[224:227]
  v_mfma_f32_16x16x32_bf16 v[228:231], v[44:47], v[200:203], v[228:231]
  v_mfma_f32_16x16x32_bf16 v[232:235], v[48:51], v[200:203], v[232:235]
  v_mfma_f32_16x16x32_bf16 v[236:239], v[52:55], v[200:203], v[236:239]
  v_mfma_f32_16x16x32_bf16 v[240:243], v[40:43], v[204:207], v[240:243]
  v_mfma_f32_16x16x32_bf16 v[244:247], v[44:47], v[204:207], v[244:247]
  v_mfma_f32_16x16x32_bf16 v[248:251], v[48:51], v[204:207], v[248:251]
  v_mfma_f32_16x16x32_bf16 v[252:255], v[52:55], v[204:207], v[252:255]
  v_mfma_f32_16x16x32_bf16 v[24:27], v[40:43], v[208:211], v[24:27]
  v_mfma_f32_16x16x32_bf16 v[28:31], v[44:47], v[208:211], v[28:31]
  v_mfma_f32_16x16x32_bf16 v[32:35], v[48:51], v[208:211], v[32:35]
  v_mfma_f32_16x16x32_bf16 v[36:39], v[52:55], v[208:211], v[36:39]
  buffer_load_dwordx4 v[40:43], v4, s[20:23], s41 offen
  buffer_load_dwordx4 v[44:47], v4, s[20:23], s41 offen offset:1024
  buffer_load_dwordx4 v[48:51], v8, s[20:23], s41 offen
  buffer_load_dwordx4 v[52:55], v8, s[20:23], s41 offen offset:1024
  ds_read_b128 v[200:203], v13 offset:384
  ds_read_b128 v[204:207], v13 offset:33408
  ds_read_b128 v[208:211], v17 offset:384
  s_waitcnt vmcnt(12)
  s_waitcnt lgkmcnt(3)
  v_mfma_f32_16x16x32_bf16 v[224:227], v[56:59], v[212:215], v[224:227]
  v_mfma_f32_16x16x32_bf16 v[228:231], v[60:63], v[212:215], v[228:231]
  v_mfma_f32_16x16x32_bf16 v[232:235], v[64:67], v[212:215], v[232:235]
  v_mfma_f32_16x16x32_bf16 v[236:239], v[68:71], v[212:215], v[236:239]
  v_mfma_f32_16x16x32_bf16 v[240:243], v[56:59], v[216:219], v[240:243]
  v_mfma_f32_16x16x32_bf16 v[244:247], v[60:63], v[216:219], v[244:247]
  v_mfma_f32_16x16x32_bf16 v[248:251], v[64:67], v[216:219], v[248:251]
  v_mfma_f32_16x16x32_bf16 v[252:255], v[68:71], v[216:219], v[252:255]
  v_mfma_f32_16x16x32_bf16 v[24:27], v[56:59], v[220:223], v[24:27]
  v_mfma_f32_16x16x32_bf16 v[28:31], v[60:63], v[220:223], v[28:31]
  v_mfma_f32_16x16x32_bf16 v[32:35], v[64:67], v[220:223], v[32:35]
  v_mfma_f32_16x16x32_bf16 v[36:39], v[68:71], v[220:223], v[36:39]
  buffer_load_dwordx4 v[56:59], v5, s[20:23], s41 offen
  buffer_load_dwordx4 v[60:63], v5, s[20:23], s41 offen offset:1024
  buffer_load_dwordx4 v[64:67], v9, s[20:23], s41 offen
  buffer_load_dwordx4 v[68:71], v9, s[20:23], s41 offen offset:1024
  ds_read_b128 v[212:215], v13 offset:448
  ds_read_b128 v[216:219], v13 offset:33472
  ds_read_b128 v[220:223], v17 offset:448
  s_waitcnt vmcnt(12)
  s_waitcnt lgkmcnt(3)
  v_mfma_f32_16x16x32_bf16 v[224:227], v[72:75], v[200:203], v[224:227]
  v_mfma_f32_16x16x32_bf16 v[228:231], v[76:79], v[200:203], v[228:231]
  v_mfma_f32_16x16x32_bf16 v[232:235], v[80:83], v[200:203], v[232:235]
  v_mfma_f32_16x16x32_bf16 v[236:239], v[84:87], v[200:203], v[236:239]
  v_mfma_f32_16x16x32_bf16 v[240:243], v[72:75], v[204:207], v[240:243]
  v_mfma_f32_16x16x32_bf16 v[244:247], v[76:79], v[204:207], v[244:247]
  v_mfma_f32_16x16x32_bf16 v[248:251], v[80:83], v[204:207], v[248:251]
  v_mfma_f32_16x16x32_bf16 v[252:255], v[84:87], v[204:207], v[252:255]
  v_mfma_f32_16x16x32_bf16 v[24:27], v[72:75], v[208:211], v[24:27]
  v_mfma_f32_16x16x32_bf16 v[28:31], v[76:79], v[208:211], v[28:31]
  v_mfma_f32_16x16x32_bf16 v[32:35], v[80:83], v[208:211], v[32:35]
  v_mfma_f32_16x16x32_bf16 v[36:39], v[84:87], v[208:211], v[36:39]
  buffer_load_dwordx4 v[72:75], v6, s[20:23], s41 offen
  buffer_load_dwordx4 v[76:79], v6, s[20:23], s41 offen offset:1024
  buffer_load_dwordx4 v[80:83], v10, s[20:23], s41 offen
  buffer_load_dwordx4 v[84:87], v10, s[20:23], s41 offen offset:1024
  ds_read_b128 v[200:203], v14 offset:256
  ds_read_b128 v[204:207], v14 offset:33280
  ds_read_b128 v[208:211], v18 offset:256
  s_waitcnt vmcnt(12)
  s_waitcnt lgkmcnt(3)
  v_mfma_f32_16x16x32_bf16 v[224:227], v[88:91], v[212:215], v[224:227]
  v_mfma_f32_16x16x32_bf16 v[228:231], v[92:95], v[212:215], v[228:231]
  v_mfma_f32_16x16x32_bf16 v[232:235], v[96:99], v[212:215], v[232:235]
  v_mfma_f32_16x16x32_bf16 v[236:239], v[100:103], v[212:215], v[236:239]
  v_mfma_f32_16x16x32_bf16 v[240:243], v[88:91], v[216:219], v[240:243]
  v_mfma_f32_16x16x32_bf16 v[244:247], v[92:95], v[216:219], v[244:247]
  v_mfma_f32_16x16x32_bf16 v[248:251], v[96:99], v[216:219], v[248:251]
  v_mfma_f32_16x16x32_bf16 v[252:255], v[100:103], v[216:219], v[252:255]
  v_mfma_f32_16x16x32_bf16 v[24:27], v[88:91], v[220:223], v[24:27]
  v_mfma_f32_16x16x32_bf16 v[28:31], v[92:95], v[220:223], v[28:31]
  v_mfma_f32_16x16x32_bf16 v[32:35], v[96:99], v[220:223], v[32:35]
  v_mfma_f32_16x16x32_bf16 v[36:39], v[100:103], v[220:223], v[36:39]
  buffer_load_dwordx4 v[88:91], v7, s[20:23], s41 offen
  buffer_load_dwordx4 v[92:95], v7, s[20:23], s41 offen offset:1024
  buffer_load_dwordx4 v[96:99], v11, s[20:23], s41 offen
  buffer_load_dwordx4 v[100:103], v11, s[20:23], s41 offen offset:1024
  ds_read_b128 v[212:215], v14 offset:320
  ds_read_b128 v[216:219], v14 offset:33344
  ds_read_b128 v[220:223], v18 offset:320
  s_waitcnt vmcnt(12)
  s_waitcnt lgkmcnt(3)
  v_mfma_f32_16x16x32_bf16 v[224:227], v[40:43], v[200:203], v[224:227]
  v_mfma_f32_16x16x32_bf16 v[228:231], v[44:47], v[200:203], v[228:231]
  v_mfma_f32_16x16x32_bf16 v[232:235], v[48:51], v[200:203], v[232:235]
  v_mfma_f32_16x16x32_bf16 v[236:239], v[52:55], v[200:203], v[236:239]
  v_mfma_f32_16x16x32_bf16 v[240:243], v[40:43], v[204:207], v[240:243]
  v_mfma_f32_16x16x32_bf16 v[244:247], v[44:47], v[204:207], v[244:247]
  v_mfma_f32_16x16x32_bf16 v[248:251], v[48:51], v[204:207], v[248:251]
  v_mfma_f32_16x16x32_bf16 v[252:255], v[52:55], v[204:207], v[252:255]
  v_mfma_f32_16x16x32_bf16 v[24:27], v[40:43], v[208:211], v[24:27]
  v_mfma_f32_16x16x32_bf16 v[28:31], v[44:47], v[208:211], v[28:31]
  v_mfma_f32_16x16x32_bf16 v[32:35], v[48:51], v[208:211], v[32:35]
  v_mfma_f32_16x16x32_bf16 v[36:39], v[52:55], v[208:211], v[36:39]
  buffer_load_dwordx4 v[40:43], v4, s[20:23], s43 offen
  buffer_load_dwordx4 v[44:47], v4, s[20:23], s43 offen offset:1024
  buffer_load_dwordx4 v[48:51], v8, s[20:23], s43 offen
  buffer_load_dwordx4 v[52:55], v8, s[20:23], s43 offen offset:1024
  ds_read_b128 v[200:203], v14 offset:384
  ds_read_b128 v[204:207], v14 offset:33408
  ds_read_b128 v[208:211], v18 offset:384
  s_waitcnt vmcnt(12)
  s_waitcnt lgkmcnt(3)
  v_mfma_f32_16x16x32_bf16 v[224:227], v[56:59], v[212:215], v[224:227]
  v_mfma_f32_16x16x32_bf16 v[228:231], v[60:63], v[212:215], v[228:231]
  v_mfma_f32_16x16x32_bf16 v[232:235], v[64:67], v[212:215], v[232:235]
  v_mfma_f32_16x16x32_bf16 v[236:239], v[68:71], v[212:215], v[236:239]
  v_mfma_f32_16x16x32_bf16 v[240:243], v[56:59], v[216:219], v[240:243]
  v_mfma_f32_16x16x32_bf16 v[244:247], v[60:63], v[216:219], v[244:247]
  v_mfma_f32_16x16x32_bf16 v[248:251], v[64:67], v[216:219], v[248:251]
  v_mfma_f32_16x16x32_bf16 v[252:255], v[68:71], v[216:219], v[252:255]
  v_mfma_f32_16x16x32_bf16 v[24:27], v[56:59], v[220:223], v[24:27]
  v_mfma_f32_16x16x32_bf16 v[28:31], v[60:63], v[220:223], v[28:31]
  v_mfma_f32_16x16x32_bf16 v[32:35], v[64:67], v[220:223], v[32:35]
  v_mfma_f32_16x16x32_bf16 v[36:39], v[68:71], v[220:223], v[36:39]
  buffer_load_dwordx4 v[56:59], v5, s[20:23], s43 offen
  buffer_load_dwordx4 v[60:63], v5, s[20:23], s43 offen offset:1024
  buffer_load_dwordx4 v[64:67], v9, s[20:23], s43 offen
  buffer_load_dwordx4 v[68:71], v9, s[20:23], s43 offen offset:1024
  ds_read_b128 v[212:215], v14 offset:448
  ds_read_b128 v[216:219], v14 offset:33472
  ds_read_b128 v[220:223], v18 offset:448
  s_waitcnt vmcnt(12)
  s_waitcnt lgkmcnt(3)
  v_mfma_f32_16x16x32_bf16 v[224:227], v[72:75], v[200:203], v[224:227]
  v_mfma_f32_16x16x32_bf16 v[228:231], v[76:79], v[200:203], v[228:231]
  v_mfma_f32_16x16x32_bf16 v[232:235], v[80:83], v[200:203], v[232:235]
  v_mfma_f32_16x16x32_bf16 v[236:239], v[84:87], v[200:203], v[236:239]
  v_mfma_f32_16x16x32_bf16 v[240:243], v[72:75], v[204:207], v[240:243]
  v_mfma_f32_16x16x32_bf16 v[244:247], v[76:79], v[204:207], v[244:247]
  v_mfma_f32_16x16x32_bf16 v[248:251], v[80:83], v[204:207], v[248:251]
  v_mfma_f32_16x16x32_bf16 v[252:255], v[84:87], v[204:207], v[252:255]
  v_mfma_f32_16x16x32_bf16 v[24:27], v[72:75], v[208:211], v[24:27]
  v_mfma_f32_16x16x32_bf16 v[28:31], v[76:79], v[208:211], v[28:31]
  v_mfma_f32_16x16x32_bf16 v[32:35], v[80:83], v[208:211], v[32:35]
  v_mfma_f32_16x16x32_bf16 v[36:39], v[84:87], v[208:211], v[36:39]
  buffer_load_dwordx4 v[72:75], v6, s[20:23], s43 offen
  buffer_load_dwordx4 v[76:79], v6, s[20:23], s43 offen offset:1024
  buffer_load_dwordx4 v[80:83], v10, s[20:23], s43 offen
  buffer_load_dwordx4 v[84:87], v10, s[20:23], s43 offen offset:1024
  ds_read_b128 v[200:203], v15 offset:256
  ds_read_b128 v[204:207], v15 offset:33280
  ds_read_b128 v[208:211], v19 offset:256
  s_waitcnt vmcnt(12)
  s_waitcnt lgkmcnt(3)
  v_mfma_f32_16x16x32_bf16 v[224:227], v[88:91], v[212:215], v[224:227]
  v_mfma_f32_16x16x32_bf16 v[228:231], v[92:95], v[212:215], v[228:231]
  v_mfma_f32_16x16x32_bf16 v[232:235], v[96:99], v[212:215], v[232:235]
  v_mfma_f32_16x16x32_bf16 v[236:239], v[100:103], v[212:215], v[236:239]
  v_mfma_f32_16x16x32_bf16 v[240:243], v[88:91], v[216:219], v[240:243]
  v_mfma_f32_16x16x32_bf16 v[244:247], v[92:95], v[216:219], v[244:247]
  v_mfma_f32_16x16x32_bf16 v[248:251], v[96:99], v[216:219], v[248:251]
  v_mfma_f32_16x16x32_bf16 v[252:255], v[100:103], v[216:219], v[252:255]
  v_mfma_f32_16x16x32_bf16 v[24:27], v[88:91], v[220:223], v[24:27]
  v_mfma_f32_16x16x32_bf16 v[28:31], v[92:95], v[220:223], v[28:31]
  v_mfma_f32_16x16x32_bf16 v[32:35], v[96:99], v[220:223], v[32:35]
  v_mfma_f32_16x16x32_bf16 v[36:39], v[100:103], v[220:223], v[36:39]
  buffer_load_dwordx4 v[88:91], v7, s[20:23], s43 offen
  buffer_load_dwordx4 v[92:95], v7, s[20:23], s43 offen offset:1024
  buffer_load_dwordx4 v[96:99], v11, s[20:23], s43 offen
  buffer_load_dwordx4 v[100:103], v11, s[20:23], s43 offen offset:1024
  ds_read_b128 v[212:215], v15 offset:320
  ds_read_b128 v[216:219], v15 offset:33344
  ds_read_b128 v[220:223], v19 offset:320
  s_waitcnt vmcnt(12)
  s_waitcnt lgkmcnt(3)
  v_mfma_f32_16x16x32_bf16 v[224:227], v[40:43], v[200:203], v[224:227]
  v_mfma_f32_16x16x32_bf16 v[228:231], v[44:47], v[200:203], v[228:231]
  v_mfma_f32_16x16x32_bf16 v[232:235], v[48:51], v[200:203], v[232:235]
  v_mfma_f32_16x16x32_bf16 v[236:239], v[52:55], v[200:203], v[236:239]
  v_mfma_f32_16x16x32_bf16 v[240:243], v[40:43], v[204:207], v[240:243]
  v_mfma_f32_16x16x32_bf16 v[244:247], v[44:47], v[204:207], v[244:247]
  v_mfma_f32_16x16x32_bf16 v[248:251], v[48:51], v[204:207], v[248:251]
  v_mfma_f32_16x16x32_bf16 v[252:255], v[52:55], v[204:207], v[252:255]
  v_mfma_f32_16x16x32_bf16 v[24:27], v[40:43], v[208:211], v[24:27]
  v_mfma_f32_16x16x32_bf16 v[28:31], v[44:47], v[208:211], v[28:31]
  v_mfma_f32_16x16x32_bf16 v[32:35], v[48:51], v[208:211], v[32:35]
  v_mfma_f32_16x16x32_bf16 v[36:39], v[52:55], v[208:211], v[36:39]
  ds_read_b128 v[200:203], v15 offset:384
  ds_read_b128 v[204:207], v15 offset:33408
  ds_read_b128 v[208:211], v19 offset:384
  s_waitcnt vmcnt(8)
  s_waitcnt lgkmcnt(3)
  v_mfma_f32_16x16x32_bf16 v[224:227], v[56:59], v[212:215], v[224:227]
  v_mfma_f32_16x16x32_bf16 v[228:231], v[60:63], v[212:215], v[228:231]
  v_mfma_f32_16x16x32_bf16 v[232:235], v[64:67], v[212:215], v[232:235]
  v_mfma_f32_16x16x32_bf16 v[236:239], v[68:71], v[212:215], v[236:239]
  v_mfma_f32_16x16x32_bf16 v[240:243], v[56:59], v[216:219], v[240:243]
  v_mfma_f32_16x16x32_bf16 v[244:247], v[60:63], v[216:219], v[244:247]
  v_mfma_f32_16x16x32_bf16 v[248:251], v[64:67], v[216:219], v[248:251]
  v_mfma_f32_16x16x32_bf16 v[252:255], v[68:71], v[216:219], v[252:255]
  v_mfma_f32_16x16x32_bf16 v[24:27], v[56:59], v[220:223], v[24:27]
  v_mfma_f32_16x16x32_bf16 v[28:31], v[60:63], v[220:223], v[28:31]
  v_mfma_f32_16x16x32_bf16 v[32:35], v[64:67], v[220:223], v[32:35]
  v_mfma_f32_16x16x32_bf16 v[36:39], v[68:71], v[220:223], v[36:39]
  ds_read_b128 v[212:215], v15 offset:448
  ds_read_b128 v[216:219], v15 offset:33472
  ds_read_b128 v[220:223], v19 offset:448
  s_waitcnt vmcnt(4)
  s_waitcnt lgkmcnt(3)
  v_mfma_f32_16x16x32_bf16 v[224:227], v[72:75], v[200:203], v[224:227]
  v_mfma_f32_16x16x32_bf16 v[228:231], v[76:79], v[200:203], v[228:231]
  v_mfma_f32_16x16x32_bf16 v[232:235], v[80:83], v[200:203], v[232:235]
  v_mfma_f32_16x16x32_bf16 v[236:239], v[84:87], v[200:203], v[236:239]
  v_mfma_f32_16x16x32_bf16 v[240:243], v[72:75], v[204:207], v[240:243]
  v_mfma_f32_16x16x32_bf16 v[244:247], v[76:79], v[204:207], v[244:247]
  v_mfma_f32_16x16x32_bf16 v[248:251], v[80:83], v[204:207], v[248:251]
  v_mfma_f32_16x16x32_bf16 v[252:255], v[84:87], v[204:207], v[252:255]
  v_mfma_f32_16x16x32_bf16 v[24:27], v[72:75], v[208:211], v[24:27]
  v_mfma_f32_16x16x32_bf16 v[28:31], v[76:79], v[208:211], v[28:31]
  v_mfma_f32_16x16x32_bf16 v[32:35], v[80:83], v[208:211], v[32:35]
  v_mfma_f32_16x16x32_bf16 v[36:39], v[84:87], v[208:211], v[36:39]
  s_waitcnt vmcnt(0)
  s_waitcnt lgkmcnt(0)
  v_mfma_f32_16x16x32_bf16 v[224:227], v[88:91], v[212:215], v[224:227]
  v_mfma_f32_16x16x32_bf16 v[228:231], v[92:95], v[212:215], v[228:231]
  v_mfma_f32_16x16x32_bf16 v[232:235], v[96:99], v[212:215], v[232:235]
  v_mfma_f32_16x16x32_bf16 v[236:239], v[100:103], v[212:215], v[236:239]
  v_mfma_f32_16x16x32_bf16 v[240:243], v[88:91], v[216:219], v[240:243]
  v_mfma_f32_16x16x32_bf16 v[244:247], v[92:95], v[216:219], v[244:247]
  v_mfma_f32_16x16x32_bf16 v[248:251], v[96:99], v[216:219], v[248:251]
  v_mfma_f32_16x16x32_bf16 v[252:255], v[100:103], v[216:219], v[252:255]
  v_mfma_f32_16x16x32_bf16 v[24:27], v[88:91], v[220:223], v[24:27]
  v_mfma_f32_16x16x32_bf16 v[28:31], v[92:95], v[220:223], v[28:31]
  v_mfma_f32_16x16x32_bf16 v[32:35], v[96:99], v[220:223], v[32:35]
  v_mfma_f32_16x16x32_bf16 v[36:39], v[100:103], v[220:223], v[36:39]
  v_add_u32 v6, s29, v2
  v_lshlrev_b32 v6, 9, v6
  v_lshl_add_u32 v6, v3, 4, v6
  s_and_b32 s60, s28, 3
  s_lshl_b32 s60, s60, 7
  v_add_u32 v6, s60, v6
  v_add_u32 v7, 0x2000, v6
  v_add_u32 v8, 0x4000, v6
  v_cmp_gt_u32 vcc, 8, v2
  s_nop 4
  v_cvt_pk_bf16_f32 v40, v224, v225
  v_cvt_pk_bf16_f32 v41, v226, v227
  v_cvt_pk_bf16_f32 v42, v228, v229
  v_cvt_pk_bf16_f32 v43, v230, v231
  global_store_dwordx4 v6, v[40:43], s[12:13] offset:0
  v_cvt_pk_bf16_f32 v44, v232, v233
  v_cvt_pk_bf16_f32 v45, v234, v235
  v_cvt_pk_bf16_f32 v46, v236, v237
  v_cvt_pk_bf16_f32 v47, v238, v239
  global_store_dwordx4 v6, v[44:47], s[12:13] offset:64
  v_cvt_pk_bf16_f32 v48, v240, v241
  v_cvt_pk_bf16_f32 v49, v242, v243
  v_cvt_pk_bf16_f32 v50, v244, v245
  v_cvt_pk_bf16_f32 v51, v246, v247
  global_store_dwordx4 v7, v[48:51], s[12:13] offset:0
  v_cvt_pk_bf16_f32 v52, v248, v249
  v_cvt_pk_bf16_f32 v53, v250, v251
  v_cvt_pk_bf16_f32 v54, v252, v253
  v_cvt_pk_bf16_f32 v55, v254, v255
  global_store_dwordx4 v7, v[52:55], s[12:13] offset:64
  s_and_saveexec_b64 s[34:35], vcc
  v_cvt_pk_bf16_f32 v56, v24, v25
  v_cvt_pk_bf16_f32 v57, v26, v27
  v_cvt_pk_bf16_f32 v58, v28, v29
  v_cvt_pk_bf16_f32 v59, v30, v31
  global_store_dwordx4 v8, v[56:59], s[12:13] offset:0
  v_cvt_pk_bf16_f32 v60, v32, v33
  v_cvt_pk_bf16_f32 v61, v34, v35
  v_cvt_pk_bf16_f32 v62, v36, v37
  v_cvt_pk_bf16_f32 v63, v38, v39
  global_store_dwordx4 v8, v[60:63], s[12:13] offset:64
  s_mov_b64 exec, -1
KB_END:
  s_endpgm
.section .rodata,"a"
.p2align 6
.amdhsa_kernel gat_prep_kernel
  .amdhsa_next_free_vgpr 104
  .amdhsa_next_free_sgpr 102
  .amdhsa_accum_offset 104
  .amdhsa_group_segment_fixed_size 0
  .amdhsa_kernarg_size 72
  .amdhsa_user_sgpr_count 2
  .amdhsa_user_sgpr_kernarg_segment_ptr 1
  .amdhsa_system_sgpr_workgroup_id_x 1
.end_amdhsa_kernel
.p2align 6
.amdhsa_kernel gat_main_kernel
  .amdhsa_next_free_vgpr 256
  .amdhsa_next_free_sgpr 102
  .amdhsa_accum_offset 256
  .amdhsa_group_segment_fixed_size 0
  .amdhsa_kernarg_size 72
  .amdhsa_user_sgpr_count 2
  .amdhsa_user_sgpr_kernarg_segment_ptr 1
  .amdhsa_system_sgpr_workgroup_id_x 1
.end_amdhsa_kernel
```
